```python
import torch

def _softmax(x, axis=-1):
    return torch.softmax(x, dim=axis)
def _gelu(x):
    return torch.nn.functional.gelu(x, approximate="tanh")
def _silu(x):
    return torch.nn.functional.silu(x)
def _sigmoid(x):
    return torch.sigmoid(x)
def _layernorm(x, axis=-1, eps=1e-5):
    m = x.mean(dim=axis, keepdim=True)
    v = x.var(dim=axis, keepdim=True, unbiased=False)
    return (x - m) / torch.sqrt(v + eps)
def _scatter_add(tgt, idx, src, axis=0):
    return tgt.clone().index_add_(axis, idx, src)
def _segment_sum(src, seg, n):
    out = torch.zeros((n,) + src.shape[1:], dtype=src.dtype)
    return out.index_add_(0, seg, src)
def _pad(x, pw):
    flat = tuple(v for pair in reversed(pw) for v in pair)
    return torch.nn.functional.pad(x, flat)

kernel_name = 'standalone__gqa_block_cached__near_ridge'

def setup_inputs():

    _w = (lambda a: (lambda t: t.to(torch.bfloat16) if t.is_floating_point() else t)(torch.as_tensor(a)))
    B, Sq, D = 8, 96, 512
    Hq, Hkv, Sk, Dh = 32, 32, 512, 128
    assert Hq % Hkv == 0, (Hq, Hkv)
    return {
        "x": _w((lambda *s: torch.randn(*s, dtype=torch.bfloat16) * 0.8)(B, Sq, D)),
        "k_cache": _w((lambda *s: torch.randn(*s, dtype=torch.bfloat16) * 0.8)(B, Hkv, Sk, Dh)),
        "v_cache": _w((lambda *s: torch.randn(*s, dtype=torch.bfloat16) * 0.05)(B, Hkv, Sk, Dh)),
        "wq": _w((lambda *s: torch.randn(*s, dtype=torch.bfloat16) * 0.8)(D, Hq * Dh) * (D ** -0.5)),
        "wo": _w((lambda *s: torch.randn(*s, dtype=torch.bfloat16) * 0.05)(Hq * Dh, D) * ((Hq * Dh) ** -0.5)),
    }

def reference(x, k_cache, v_cache, wq, wo):
    B, Sq, D = x.shape
    Hq, Dh = 32, 128
    Hkv = k_cache.shape[1]
    rep = Hq // Hkv
    q = (lambda x, *d: x.permute(*d))((x @ wq).reshape(B, Sq, Hq, Dh), 0, 2, 1, 3)
    k = (lambda x, n, axis: torch.repeat_interleave(x, n, dim=axis))(k_cache, rep, axis=1)
    v = (lambda x, n, axis: torch.repeat_interleave(x, n, dim=axis))(v_cache, rep, axis=1)
    scores = torch.einsum("bhqd,bhkd->bhqk", q, k) * (Dh ** -0.5)
    p = _softmax(scores, axis=-1)
    o = torch.einsum("bhqk,bhkd->bhqd", p, v)
    return (lambda x, *d: x.permute(*d))(o, 0, 2, 1, 3).reshape(B, Sq, Hq * Dh) @ wo
```

```asm
; @launch kernel=standalone__gqa_block_cached__near_ridge_kernel grid=(256,1,1) block=(512,1,1) lds=163840
; @launch kernel=oproj_kernel grid=(256,1,1) block=(256,1,1) lds=24576
.amdgcn_target "amdgcn-amd-amdhsa--gfx950"
.text
.globl standalone__gqa_block_cached__near_ridge_kernel
.p2align 8
.type standalone__gqa_block_cached__near_ridge_kernel,@function
standalone__gqa_block_cached__near_ridge_kernel:
    s_cmp_ge_u32 s2, 256
    s_cbranch_scc1 K1_END
    s_load_dwordx16 s[4:19], s[0:1], 0
    v_lshrrev_b32 v32, 6, v0
    v_and_b32 v34, 63, v0
    v_and_b32 v33, 3, v32
    v_readfirstlane_b32 s47, v32
    v_readfirstlane_b32 s46, v33
    v_and_b32 v35, 15, v34
    v_lshrrev_b32 v36, 4, v34
    s_lshr_b32 s44, s2, 5
    s_and_b32 s50, s2, 7
    s_lshl_b32 s50, s50, 2
    s_lshr_b32 s51, s2, 3
    s_and_b32 s51, s51, 3
    s_add_u32 s45, s50, s51
    v_lshlrev_b32 v255, 4, v34
    v_lshlrev_b32 v38, 4, v35
    v_lshlrev_b32 v43, 8, v35
    s_cmp_ge_u32 s47, 4
    s_cbranch_scc1 K1_LOADER
    v_lshrrev_b32 v39, 2, v35
    v_and_b32 v40, 1, v36
    v_lshl_add_u32 v40, v40, 2, v39
    v_lshl_add_u32 v41, v36, 3, v39
    v_and_b32 v42, 3, v35
    v_lshlrev_b32 v42, 3, v42
    v_lshl_add_u32 v41, v41, 8, v42
    v_add_u32 v41, 98304, v41
    v_lshlrev_b32 v42, 1, v33
    v_xor_b32 v42, v42, v40
    v_lshl_add_u32 v242, v42, 5, v41
    v_xor_b32 v42, 1, v42
    v_lshl_add_u32 v243, v42, 5, v41
    v_lshrrev_b32 v39, 1, v36
    v_lshl_add_u32 v39, v39, 8, v38
    v_and_b32 v40, 1, v36
    v_lshl_add_u32 v39, v40, 3, v39
    v_lshl_add_u32 v252, v33, 10, v39
    v_add_u32 v253, 147456, v38
    v_lshl_add_u32 v254, v33, 2, v253
    s_lshl_b32 s50, s46, 12
    s_add_u32 s50, s50, 24576
    v_add_u32 v39, 0, v36
    v_xor_b32 v42, v39, v35
    v_lshl_add_u32 v244, v42, 4, v43
    v_add_u32 v248, s50, v244
    v_add_u32 v39, 4, v36
    v_xor_b32 v42, v39, v35
    v_lshl_add_u32 v245, v42, 4, v43
    v_add_u32 v249, s50, v245
    v_add_u32 v39, 8, v36
    v_xor_b32 v42, v39, v35
    v_lshl_add_u32 v246, v42, 4, v43
    v_add_u32 v250, s50, v246
    v_add_u32 v39, 12, v36
    v_xor_b32 v42, v39, v35
    v_lshl_add_u32 v247, v42, 4, v43
    v_add_u32 v251, s50, v247
    s_mov_b32 s53, 0
    s_waitcnt lgkmcnt(0)
    s_mov_b32 s40, s18
    s_and_b32 s41, s19, 0xffff
    s_mov_b32 s42, 268435456
    s_mov_b32 s43, 0x00020000
    s_barrier
K1_GEMM:
    s_mov_b32 s52, 0
    ds_read_b64_tr_b16 v[96:97], v242 offset:0
    ds_read_b64_tr_b16 v[98:99], v242 offset:1024
    ds_read_b64_tr_b16 v[100:101], v243 offset:0
    ds_read_b64_tr_b16 v[102:103], v243 offset:1024
    ds_read_b128 v[48:51], v244 offset:0
    ds_read_b128 v[52:55], v244 offset:4096
    ds_read_b128 v[56:59], v244 offset:8192
    ds_read_b128 v[60:63], v244 offset:12288
    ds_read_b128 v[64:67], v244 offset:16384
    ds_read_b128 v[68:71], v244 offset:20480
    v_mov_b32 v0, 0
    v_mov_b32 v1, 0
    v_mov_b32 v2, 0
    v_mov_b32 v3, 0
    v_mov_b32 v4, 0
    v_mov_b32 v5, 0
    v_mov_b32 v6, 0
    v_mov_b32 v7, 0
    v_mov_b32 v8, 0
    v_mov_b32 v9, 0
    v_mov_b32 v10, 0
    v_mov_b32 v11, 0
    v_mov_b32 v12, 0
    v_mov_b32 v13, 0
    v_mov_b32 v14, 0
    v_mov_b32 v15, 0
    v_mov_b32 v16, 0
    v_mov_b32 v17, 0
    v_mov_b32 v18, 0
    v_mov_b32 v19, 0
    v_mov_b32 v20, 0
    v_mov_b32 v21, 0
    v_mov_b32 v22, 0
    v_mov_b32 v23, 0
    v_mov_b32 v24, 0
    v_mov_b32 v25, 0
    v_mov_b32 v26, 0
    v_mov_b32 v27, 0
    v_mov_b32 v28, 0
    v_mov_b32 v29, 0
    v_mov_b32 v30, 0
    v_mov_b32 v31, 0
    v_mov_b32 v32, 0
    v_mov_b32 v33, 0
    v_mov_b32 v34, 0
    v_mov_b32 v35, 0
    v_mov_b32 v36, 0
    v_mov_b32 v37, 0
    v_mov_b32 v38, 0
    v_mov_b32 v39, 0
    v_mov_b32 v40, 0
    v_mov_b32 v41, 0
    v_mov_b32 v42, 0
    v_mov_b32 v43, 0
    v_mov_b32 v44, 0
    v_mov_b32 v45, 0
    v_mov_b32 v46, 0
    v_mov_b32 v47, 0
K1_LOOP:
    s_waitcnt lgkmcnt(0)
    s_barrier
    v_mfma_f32_16x16x32_bf16 v[0:3], v[96:99], v[48:51], v[0:3]
    ds_read_b64_tr_b16 v[104:105], v242 offset:8192
    ds_read_b64_tr_b16 v[106:107], v242 offset:9216
    v_mfma_f32_16x16x32_bf16 v[4:7], v[100:103], v[48:51], v[4:7]
    ds_read_b64_tr_b16 v[108:109], v243 offset:8192
    ds_read_b64_tr_b16 v[110:111], v243 offset:9216
    v_mfma_f32_16x16x32_bf16 v[8:11], v[96:99], v[52:55], v[8:11]
    ds_read_b128 v[72:75], v245 offset:0
    ds_read_b128 v[76:79], v245 offset:4096
    v_mfma_f32_16x16x32_bf16 v[12:15], v[100:103], v[52:55], v[12:15]
    ds_read_b128 v[80:83], v245 offset:8192
    ds_read_b128 v[84:87], v245 offset:12288
    v_mfma_f32_16x16x32_bf16 v[16:19], v[96:99], v[56:59], v[16:19]
    ds_read_b128 v[88:91], v245 offset:16384
    ds_read_b128 v[92:95], v245 offset:20480
    v_mfma_f32_16x16x32_bf16 v[20:23], v[100:103], v[56:59], v[20:23]
    v_mfma_f32_16x16x32_bf16 v[24:27], v[96:99], v[60:63], v[24:27]
    v_mfma_f32_16x16x32_bf16 v[28:31], v[100:103], v[60:63], v[28:31]
    v_mfma_f32_16x16x32_bf16 v[32:35], v[96:99], v[64:67], v[32:35]
    v_mfma_f32_16x16x32_bf16 v[36:39], v[100:103], v[64:67], v[36:39]
    v_mfma_f32_16x16x32_bf16 v[40:43], v[96:99], v[68:71], v[40:43]
    v_mfma_f32_16x16x32_bf16 v[44:47], v[100:103], v[68:71], v[44:47]
    s_waitcnt lgkmcnt(0)
    v_mfma_f32_16x16x32_bf16 v[0:3], v[104:107], v[72:75], v[0:3]
    ds_read_b64_tr_b16 v[96:97], v242 offset:16384
    ds_read_b64_tr_b16 v[98:99], v242 offset:17408
    v_mfma_f32_16x16x32_bf16 v[4:7], v[108:111], v[72:75], v[4:7]
    ds_read_b64_tr_b16 v[100:101], v243 offset:16384
    ds_read_b64_tr_b16 v[102:103], v243 offset:17408
    v_mfma_f32_16x16x32_bf16 v[8:11], v[104:107], v[76:79], v[8:11]
    ds_read_b128 v[48:51], v246 offset:0
    ds_read_b128 v[52:55], v246 offset:4096
    v_mfma_f32_16x16x32_bf16 v[12:15], v[108:111], v[76:79], v[12:15]
    ds_read_b128 v[56:59], v246 offset:8192
    ds_read_b128 v[60:63], v246 offset:12288
    v_mfma_f32_16x16x32_bf16 v[16:19], v[104:107], v[80:83], v[16:19]
    ds_read_b128 v[64:67], v246 offset:16384
    ds_read_b128 v[68:71], v246 offset:20480
    v_mfma_f32_16x16x32_bf16 v[20:23], v[108:111], v[80:83], v[20:23]
    v_mfma_f32_16x16x32_bf16 v[24:27], v[104:107], v[84:87], v[24:27]
    v_mfma_f32_16x16x32_bf16 v[28:31], v[108:111], v[84:87], v[28:31]
    v_mfma_f32_16x16x32_bf16 v[32:35], v[104:107], v[88:91], v[32:35]
    v_mfma_f32_16x16x32_bf16 v[36:39], v[108:111], v[88:91], v[36:39]
    v_mfma_f32_16x16x32_bf16 v[40:43], v[104:107], v[92:95], v[40:43]
    v_mfma_f32_16x16x32_bf16 v[44:47], v[108:111], v[92:95], v[44:47]
    s_waitcnt lgkmcnt(0)
    s_barrier
    v_mfma_f32_16x16x32_bf16 v[0:3], v[96:99], v[48:51], v[0:3]
    ds_read_b64_tr_b16 v[104:105], v242 offset:24576
    ds_read_b64_tr_b16 v[106:107], v242 offset:25600
    v_mfma_f32_16x16x32_bf16 v[4:7], v[100:103], v[48:51], v[4:7]
    ds_read_b64_tr_b16 v[108:109], v243 offset:24576
    ds_read_b64_tr_b16 v[110:111], v243 offset:25600
    v_mfma_f32_16x16x32_bf16 v[8:11], v[96:99], v[52:55], v[8:11]
    ds_read_b128 v[72:75], v247 offset:0
    ds_read_b128 v[76:79], v247 offset:4096
    v_mfma_f32_16x16x32_bf16 v[12:15], v[100:103], v[52:55], v[12:15]
    ds_read_b128 v[80:83], v247 offset:8192
    ds_read_b128 v[84:87], v247 offset:12288
    v_mfma_f32_16x16x32_bf16 v[16:19], v[96:99], v[56:59], v[16:19]
    ds_read_b128 v[88:91], v247 offset:16384
    ds_read_b128 v[92:95], v247 offset:20480
    v_mfma_f32_16x16x32_bf16 v[20:23], v[100:103], v[56:59], v[20:23]
    v_mfma_f32_16x16x32_bf16 v[24:27], v[96:99], v[60:63], v[24:27]
    v_mfma_f32_16x16x32_bf16 v[28:31], v[100:103], v[60:63], v[28:31]
    v_mfma_f32_16x16x32_bf16 v[32:35], v[96:99], v[64:67], v[32:35]
    v_mfma_f32_16x16x32_bf16 v[36:39], v[100:103], v[64:67], v[36:39]
    v_mfma_f32_16x16x32_bf16 v[40:43], v[96:99], v[68:71], v[40:43]
    v_mfma_f32_16x16x32_bf16 v[44:47], v[100:103], v[68:71], v[44:47]
    v_add_u32 v244, 24576, v244
    v_xor_b32 v242, 0x38000, v242
    v_xor_b32 v243, 0x38000, v243
    s_waitcnt lgkmcnt(0)
    v_mfma_f32_16x16x32_bf16 v[0:3], v[104:107], v[72:75], v[0:3]
    ds_read_b64_tr_b16 v[96:97], v242 offset:0
    ds_read_b64_tr_b16 v[98:99], v242 offset:1024
    v_mfma_f32_16x16x32_bf16 v[4:7], v[108:111], v[72:75], v[4:7]
    ds_read_b64_tr_b16 v[100:101], v243 offset:0
    ds_read_b64_tr_b16 v[102:103], v243 offset:1024
    v_mfma_f32_16x16x32_bf16 v[8:11], v[104:107], v[76:79], v[8:11]
    ds_read_b128 v[48:51], v244 offset:0
    ds_read_b128 v[52:55], v244 offset:4096
    v_mfma_f32_16x16x32_bf16 v[12:15], v[108:111], v[76:79], v[12:15]
    ds_read_b128 v[56:59], v244 offset:8192
    ds_read_b128 v[60:63], v244 offset:12288
    v_mfma_f32_16x16x32_bf16 v[16:19], v[104:107], v[80:83], v[16:19]
    ds_read_b128 v[64:67], v244 offset:16384
    ds_read_b128 v[68:71], v244 offset:20480
    v_mfma_f32_16x16x32_bf16 v[20:23], v[108:111], v[80:83], v[20:23]
    v_mfma_f32_16x16x32_bf16 v[24:27], v[104:107], v[84:87], v[24:27]
    v_mfma_f32_16x16x32_bf16 v[28:31], v[108:111], v[84:87], v[28:31]
    v_mfma_f32_16x16x32_bf16 v[32:35], v[104:107], v[88:91], v[32:35]
    v_mfma_f32_16x16x32_bf16 v[36:39], v[108:111], v[88:91], v[36:39]
    v_mfma_f32_16x16x32_bf16 v[40:43], v[104:107], v[92:95], v[40:43]
    v_mfma_f32_16x16x32_bf16 v[44:47], v[108:111], v[92:95], v[44:47]
    v_add_u32 v245, 24576, v245
    v_add_u32 v246, 24576, v246
    v_add_u32 v247, 24576, v247
    s_add_u32 s52, s52, 2
    s_cmp_lt_u32 s52, 8
    s_cbranch_scc1 K1_LOOP
    s_waitcnt lgkmcnt(0)
    s_barrier
    v_cvt_pk_bf16_f32 v0, v0, v1
    v_cvt_pk_bf16_f32 v1, v2, v3
    ds_write_b64 v252, v[0:1] offset:0
    v_cvt_pk_bf16_f32 v4, v4, v5
    v_cvt_pk_bf16_f32 v5, v6, v7
    ds_write_b64 v252, v[4:5] offset:512
    v_cvt_pk_bf16_f32 v8, v8, v9
    v_cvt_pk_bf16_f32 v9, v10, v11
    ds_write_b64 v252, v[8:9] offset:4096
    v_cvt_pk_bf16_f32 v12, v12, v13
    v_cvt_pk_bf16_f32 v13, v14, v15
    ds_write_b64 v252, v[12:13] offset:4608
    v_cvt_pk_bf16_f32 v16, v16, v17
    v_cvt_pk_bf16_f32 v17, v18, v19
    ds_write_b64 v252, v[16:17] offset:8192
    v_cvt_pk_bf16_f32 v20, v20, v21
    v_cvt_pk_bf16_f32 v21, v22, v23
    ds_write_b64 v252, v[20:21] offset:8704
    v_cvt_pk_bf16_f32 v24, v24, v25
    v_cvt_pk_bf16_f32 v25, v26, v27
    ds_write_b64 v252, v[24:25] offset:12288
    v_cvt_pk_bf16_f32 v28, v28, v29
    v_cvt_pk_bf16_f32 v29, v30, v31
    ds_write_b64 v252, v[28:29] offset:12800
    v_cvt_pk_bf16_f32 v32, v32, v33
    v_cvt_pk_bf16_f32 v33, v34, v35
    ds_write_b64 v252, v[32:33] offset:16384
    v_cvt_pk_bf16_f32 v36, v36, v37
    v_cvt_pk_bf16_f32 v37, v38, v39
    ds_write_b64 v252, v[36:37] offset:16896
    v_cvt_pk_bf16_f32 v40, v40, v41
    v_cvt_pk_bf16_f32 v41, v42, v43
    ds_write_b64 v252, v[40:41] offset:20480
    v_cvt_pk_bf16_f32 v44, v44, v45
    v_cvt_pk_bf16_f32 v45, v46, v47
    ds_write_b64 v252, v[44:45] offset:20992
    v_add_u32 v244, 73728, v248
    v_add_u32 v245, 73728, v249
    v_add_u32 v246, 73728, v250
    v_add_u32 v247, 73728, v251
    s_waitcnt lgkmcnt(0)
    s_barrier
    ds_read_b128 v[224:227], v255 offset:0
    ds_read_b128 v[228:231], v255 offset:1024
    ds_read_b128 v[232:235], v255 offset:2048
    ds_read_b128 v[236:239], v255 offset:3072
    ds_read_b128 v[192:195], v244 offset:0
    ds_read_b128 v[208:211], v244 offset:16384
    ds_read_b128 v[196:199], v245 offset:0
    ds_read_b128 v[212:215], v245 offset:16384
    ds_read_b128 v[200:203], v246 offset:0
    ds_read_b128 v[216:219], v246 offset:16384
    ds_read_b128 v[204:207], v247 offset:0
    ds_read_b128 v[220:223], v247 offset:16384
    ds_read_b128 v[88:91], v255 offset:4096
    ds_read_b128 v[184:187], v255 offset:5120
    ds_read_b128 v[92:95], v255 offset:6144
    ds_read_b128 v[188:191], v255 offset:7168
    s_waitcnt lgkmcnt(10)
    v_mfma_f32_16x16x32_bf16 v[0:3], v[192:195], v[224:227], 0
    v_mfma_f32_16x16x32_bf16 v[96:99], v[208:211], v[224:227], 0
    s_waitcnt lgkmcnt(8)
    v_mfma_f32_16x16x32_bf16 v[0:3], v[196:199], v[228:231], v[0:3]
    v_mfma_f32_16x16x32_bf16 v[96:99], v[212:215], v[228:231], v[96:99]
    s_waitcnt lgkmcnt(6)
    v_mfma_f32_16x16x32_bf16 v[0:3], v[200:203], v[232:235], v[0:3]
    v_mfma_f32_16x16x32_bf16 v[96:99], v[216:219], v[232:235], v[96:99]
    s_waitcnt lgkmcnt(4)
    v_mfma_f32_16x16x32_bf16 v[0:3], v[204:207], v[236:239], v[0:3]
    v_mfma_f32_16x16x32_bf16 v[96:99], v[220:223], v[236:239], v[96:99]
    ds_read_b128 v[224:227], v255 offset:8192
    ds_read_b128 v[228:231], v255 offset:9216
    ds_read_b128 v[232:235], v255 offset:10240
    ds_read_b128 v[236:239], v255 offset:11264
    s_waitcnt lgkmcnt(7)
    v_mfma_f32_16x16x32_bf16 v[4:7], v[192:195], v[88:91], 0
    v_mfma_f32_16x16x32_bf16 v[100:103], v[208:211], v[88:91], 0
    s_waitcnt lgkmcnt(6)
    v_mfma_f32_16x16x32_bf16 v[4:7], v[196:199], v[184:187], v[4:7]
    v_mfma_f32_16x16x32_bf16 v[100:103], v[212:215], v[184:187], v[100:103]
    s_waitcnt lgkmcnt(5)
    v_mfma_f32_16x16x32_bf16 v[4:7], v[200:203], v[92:95], v[4:7]
    v_mfma_f32_16x16x32_bf16 v[100:103], v[216:219], v[92:95], v[100:103]
    s_waitcnt lgkmcnt(4)
    v_mfma_f32_16x16x32_bf16 v[4:7], v[204:207], v[188:191], v[4:7]
    v_mfma_f32_16x16x32_bf16 v[100:103], v[220:223], v[188:191], v[100:103]
    ds_read_b128 v[88:91], v255 offset:12288
    ds_read_b128 v[184:187], v255 offset:13312
    ds_read_b128 v[92:95], v255 offset:14336
    ds_read_b128 v[188:191], v255 offset:15360
    s_waitcnt lgkmcnt(7)
    v_mfma_f32_16x16x32_bf16 v[8:11], v[192:195], v[224:227], 0
    v_mfma_f32_16x16x32_bf16 v[104:107], v[208:211], v[224:227], 0
    s_waitcnt lgkmcnt(6)
    v_mfma_f32_16x16x32_bf16 v[8:11], v[196:199], v[228:231], v[8:11]
    v_mfma_f32_16x16x32_bf16 v[104:107], v[212:215], v[228:231], v[104:107]
    s_waitcnt lgkmcnt(5)
    v_mfma_f32_16x16x32_bf16 v[8:11], v[200:203], v[232:235], v[8:11]
    v_mfma_f32_16x16x32_bf16 v[104:107], v[216:219], v[232:235], v[104:107]
    s_waitcnt lgkmcnt(4)
    v_mfma_f32_16x16x32_bf16 v[8:11], v[204:207], v[236:239], v[8:11]
    v_mfma_f32_16x16x32_bf16 v[104:107], v[220:223], v[236:239], v[104:107]
    ds_read_b128 v[224:227], v255 offset:16384
    ds_read_b128 v[228:231], v255 offset:17408
    ds_read_b128 v[232:235], v255 offset:18432
    ds_read_b128 v[236:239], v255 offset:19456
    s_waitcnt lgkmcnt(7)
    v_mfma_f32_16x16x32_bf16 v[12:15], v[192:195], v[88:91], 0
    v_mfma_f32_16x16x32_bf16 v[108:111], v[208:211], v[88:91], 0
    s_waitcnt lgkmcnt(6)
    v_mfma_f32_16x16x32_bf16 v[12:15], v[196:199], v[184:187], v[12:15]
    v_mfma_f32_16x16x32_bf16 v[108:111], v[212:215], v[184:187], v[108:111]
    s_waitcnt lgkmcnt(5)
    v_mfma_f32_16x16x32_bf16 v[12:15], v[200:203], v[92:95], v[12:15]
    v_mfma_f32_16x16x32_bf16 v[108:111], v[216:219], v[92:95], v[108:111]
    s_waitcnt lgkmcnt(4)
    v_mfma_f32_16x16x32_bf16 v[12:15], v[204:207], v[188:191], v[12:15]
    v_mfma_f32_16x16x32_bf16 v[108:111], v[220:223], v[188:191], v[108:111]
    ds_read_b128 v[88:91], v255 offset:20480
    ds_read_b128 v[184:187], v255 offset:21504
    ds_read_b128 v[92:95], v255 offset:22528
    ds_read_b128 v[188:191], v255 offset:23552
    s_waitcnt lgkmcnt(7)
    v_mfma_f32_16x16x32_bf16 v[16:19], v[192:195], v[224:227], 0
    v_mfma_f32_16x16x32_bf16 v[112:115], v[208:211], v[224:227], 0
    s_waitcnt lgkmcnt(6)
    v_mfma_f32_16x16x32_bf16 v[16:19], v[196:199], v[228:231], v[16:19]
    v_mfma_f32_16x16x32_bf16 v[112:115], v[212:215], v[228:231], v[112:115]
    s_waitcnt lgkmcnt(5)
    v_mfma_f32_16x16x32_bf16 v[16:19], v[200:203], v[232:235], v[16:19]
    v_mfma_f32_16x16x32_bf16 v[112:115], v[216:219], v[232:235], v[112:115]
    s_waitcnt lgkmcnt(4)
    v_mfma_f32_16x16x32_bf16 v[16:19], v[204:207], v[236:239], v[16:19]
    v_mfma_f32_16x16x32_bf16 v[112:115], v[220:223], v[236:239], v[112:115]
    ds_read_b128 v[224:227], v255 offset:0
    ds_read_b128 v[228:231], v255 offset:1024
    ds_read_b128 v[232:235], v255 offset:2048
    ds_read_b128 v[236:239], v255 offset:3072
    s_waitcnt lgkmcnt(7)
    v_mfma_f32_16x16x32_bf16 v[20:23], v[192:195], v[88:91], 0
    v_mfma_f32_16x16x32_bf16 v[116:119], v[208:211], v[88:91], 0
    s_waitcnt lgkmcnt(6)
    v_mfma_f32_16x16x32_bf16 v[20:23], v[196:199], v[184:187], v[20:23]
    v_mfma_f32_16x16x32_bf16 v[116:119], v[212:215], v[184:187], v[116:119]
    s_waitcnt lgkmcnt(5)
    v_mfma_f32_16x16x32_bf16 v[20:23], v[200:203], v[92:95], v[20:23]
    v_mfma_f32_16x16x32_bf16 v[116:119], v[216:219], v[92:95], v[116:119]
    s_waitcnt lgkmcnt(4)
    v_mfma_f32_16x16x32_bf16 v[20:23], v[204:207], v[188:191], v[20:23]
    v_mfma_f32_16x16x32_bf16 v[116:119], v[220:223], v[188:191], v[116:119]
    s_barrier
    ds_read_b128 v[192:195], v244 offset:32768
    ds_read_b128 v[208:211], v248 offset:0
    ds_read_b128 v[196:199], v245 offset:32768
    ds_read_b128 v[212:215], v249 offset:0
    ds_read_b128 v[200:203], v246 offset:32768
    ds_read_b128 v[216:219], v250 offset:0
    ds_read_b128 v[204:207], v247 offset:32768
    ds_read_b128 v[220:223], v251 offset:0
    ds_read_b128 v[88:91], v255 offset:4096
    ds_read_b128 v[184:187], v255 offset:5120
    ds_read_b128 v[92:95], v255 offset:6144
    ds_read_b128 v[188:191], v255 offset:7168
    s_waitcnt lgkmcnt(10)
    v_mfma_f32_16x16x32_bf16 v[24:27], v[192:195], v[224:227], 0
    v_mfma_f32_16x16x32_bf16 v[120:123], v[208:211], v[224:227], 0
    s_waitcnt lgkmcnt(8)
    v_mfma_f32_16x16x32_bf16 v[24:27], v[196:199], v[228:231], v[24:27]
    v_mfma_f32_16x16x32_bf16 v[120:123], v[212:215], v[228:231], v[120:123]
    s_waitcnt lgkmcnt(6)
    v_mfma_f32_16x16x32_bf16 v[24:27], v[200:203], v[232:235], v[24:27]
    v_mfma_f32_16x16x32_bf16 v[120:123], v[216:219], v[232:235], v[120:123]
    s_waitcnt lgkmcnt(4)
    v_mfma_f32_16x16x32_bf16 v[24:27], v[204:207], v[236:239], v[24:27]
    v_mfma_f32_16x16x32_bf16 v[120:123], v[220:223], v[236:239], v[120:123]
    ds_read_b128 v[224:227], v255 offset:8192
    ds_read_b128 v[228:231], v255 offset:9216
    ds_read_b128 v[232:235], v255 offset:10240
    ds_read_b128 v[236:239], v255 offset:11264
    s_waitcnt lgkmcnt(7)
    v_mfma_f32_16x16x32_bf16 v[28:31], v[192:195], v[88:91], 0
    v_mfma_f32_16x16x32_bf16 v[124:127], v[208:211], v[88:91], 0
    s_waitcnt lgkmcnt(6)
    v_mfma_f32_16x16x32_bf16 v[28:31], v[196:199], v[184:187], v[28:31]
    v_mfma_f32_16x16x32_bf16 v[124:127], v[212:215], v[184:187], v[124:127]
    s_waitcnt lgkmcnt(5)
    v_mfma_f32_16x16x32_bf16 v[28:31], v[200:203], v[92:95], v[28:31]
    v_mfma_f32_16x16x32_bf16 v[124:127], v[216:219], v[92:95], v[124:127]
    s_waitcnt lgkmcnt(4)
    v_mfma_f32_16x16x32_bf16 v[28:31], v[204:207], v[188:191], v[28:31]
    v_mfma_f32_16x16x32_bf16 v[124:127], v[220:223], v[188:191], v[124:127]
    ds_read_b128 v[88:91], v255 offset:12288
    ds_read_b128 v[184:187], v255 offset:13312
    ds_read_b128 v[92:95], v255 offset:14336
    ds_read_b128 v[188:191], v255 offset:15360
    s_waitcnt lgkmcnt(7)
    v_mfma_f32_16x16x32_bf16 v[32:35], v[192:195], v[224:227], 0
    v_mfma_f32_16x16x32_bf16 v[128:131], v[208:211], v[224:227], 0
    s_waitcnt lgkmcnt(6)
    v_mfma_f32_16x16x32_bf16 v[32:35], v[196:199], v[228:231], v[32:35]
    v_mfma_f32_16x16x32_bf16 v[128:131], v[212:215], v[228:231], v[128:131]
    s_waitcnt lgkmcnt(5)
    v_mfma_f32_16x16x32_bf16 v[32:35], v[200:203], v[232:235], v[32:35]
    v_mfma_f32_16x16x32_bf16 v[128:131], v[216:219], v[232:235], v[128:131]
    s_waitcnt lgkmcnt(4)
    v_mfma_f32_16x16x32_bf16 v[32:35], v[204:207], v[236:239], v[32:35]
    v_mfma_f32_16x16x32_bf16 v[128:131], v[220:223], v[236:239], v[128:131]
    ds_read_b128 v[224:227], v255 offset:16384
    ds_read_b128 v[228:231], v255 offset:17408
    ds_read_b128 v[232:235], v255 offset:18432
    ds_read_b128 v[236:239], v255 offset:19456
    s_waitcnt lgkmcnt(7)
    v_mfma_f32_16x16x32_bf16 v[36:39], v[192:195], v[88:91], 0
    v_mfma_f32_16x16x32_bf16 v[132:135], v[208:211], v[88:91], 0
    s_waitcnt lgkmcnt(6)
    v_mfma_f32_16x16x32_bf16 v[36:39], v[196:199], v[184:187], v[36:39]
    v_mfma_f32_16x16x32_bf16 v[132:135], v[212:215], v[184:187], v[132:135]
    s_waitcnt lgkmcnt(5)
    v_mfma_f32_16x16x32_bf16 v[36:39], v[200:203], v[92:95], v[36:39]
    v_mfma_f32_16x16x32_bf16 v[132:135], v[216:219], v[92:95], v[132:135]
    s_waitcnt lgkmcnt(4)
    v_mfma_f32_16x16x32_bf16 v[36:39], v[204:207], v[188:191], v[36:39]
    v_mfma_f32_16x16x32_bf16 v[132:135], v[220:223], v[188:191], v[132:135]
    ds_read_b128 v[88:91], v255 offset:20480
    ds_read_b128 v[184:187], v255 offset:21504
    ds_read_b128 v[92:95], v255 offset:22528
    ds_read_b128 v[188:191], v255 offset:23552
    s_waitcnt lgkmcnt(7)
    v_mfma_f32_16x16x32_bf16 v[40:43], v[192:195], v[224:227], 0
    v_mfma_f32_16x16x32_bf16 v[136:139], v[208:211], v[224:227], 0
    s_waitcnt lgkmcnt(6)
    v_mfma_f32_16x16x32_bf16 v[40:43], v[196:199], v[228:231], v[40:43]
    v_mfma_f32_16x16x32_bf16 v[136:139], v[212:215], v[228:231], v[136:139]
    s_waitcnt lgkmcnt(5)
    v_mfma_f32_16x16x32_bf16 v[40:43], v[200:203], v[232:235], v[40:43]
    v_mfma_f32_16x16x32_bf16 v[136:139], v[216:219], v[232:235], v[136:139]
    s_waitcnt lgkmcnt(4)
    v_mfma_f32_16x16x32_bf16 v[40:43], v[204:207], v[236:239], v[40:43]
    v_mfma_f32_16x16x32_bf16 v[136:139], v[220:223], v[236:239], v[136:139]
    ds_read_b128 v[224:227], v255 offset:0
    ds_read_b128 v[228:231], v255 offset:1024
    ds_read_b128 v[232:235], v255 offset:2048
    ds_read_b128 v[236:239], v255 offset:3072
    s_waitcnt lgkmcnt(7)
    v_mfma_f32_16x16x32_bf16 v[44:47], v[192:195], v[88:91], 0
    v_mfma_f32_16x16x32_bf16 v[140:143], v[208:211], v[88:91], 0
    s_waitcnt lgkmcnt(6)
    v_mfma_f32_16x16x32_bf16 v[44:47], v[196:199], v[184:187], v[44:47]
    v_mfma_f32_16x16x32_bf16 v[140:143], v[212:215], v[184:187], v[140:143]
    s_waitcnt lgkmcnt(5)
    v_mfma_f32_16x16x32_bf16 v[44:47], v[200:203], v[92:95], v[44:47]
    v_mfma_f32_16x16x32_bf16 v[140:143], v[216:219], v[92:95], v[140:143]
    s_waitcnt lgkmcnt(4)
    v_mfma_f32_16x16x32_bf16 v[44:47], v[204:207], v[188:191], v[44:47]
    v_mfma_f32_16x16x32_bf16 v[140:143], v[220:223], v[188:191], v[140:143]
    s_barrier
    ds_read_b128 v[192:195], v248 offset:16384
    ds_read_b128 v[208:211], v248 offset:32768
    ds_read_b128 v[196:199], v249 offset:16384
    ds_read_b128 v[212:215], v249 offset:32768
    ds_read_b128 v[200:203], v250 offset:16384
    ds_read_b128 v[216:219], v250 offset:32768
    ds_read_b128 v[204:207], v251 offset:16384
    ds_read_b128 v[220:223], v251 offset:32768
    ds_read_b128 v[88:91], v255 offset:4096
    ds_read_b128 v[184:187], v255 offset:5120
    ds_read_b128 v[92:95], v255 offset:6144
    ds_read_b128 v[188:191], v255 offset:7168
    s_waitcnt lgkmcnt(10)
    v_mfma_f32_16x16x32_bf16 v[48:51], v[192:195], v[224:227], 0
    v_mfma_f32_16x16x32_bf16 v[144:147], v[208:211], v[224:227], 0
    s_waitcnt lgkmcnt(8)
    v_mfma_f32_16x16x32_bf16 v[48:51], v[196:199], v[228:231], v[48:51]
    v_mfma_f32_16x16x32_bf16 v[144:147], v[212:215], v[228:231], v[144:147]
    s_waitcnt lgkmcnt(6)
    v_mfma_f32_16x16x32_bf16 v[48:51], v[200:203], v[232:235], v[48:51]
    v_mfma_f32_16x16x32_bf16 v[144:147], v[216:219], v[232:235], v[144:147]
    s_waitcnt lgkmcnt(4)
    v_mfma_f32_16x16x32_bf16 v[48:51], v[204:207], v[236:239], v[48:51]
    v_mfma_f32_16x16x32_bf16 v[144:147], v[220:223], v[236:239], v[144:147]
    ds_read_b128 v[224:227], v255 offset:8192
    ds_read_b128 v[228:231], v255 offset:9216
    ds_read_b128 v[232:235], v255 offset:10240
    ds_read_b128 v[236:239], v255 offset:11264
    s_waitcnt lgkmcnt(7)
    v_mfma_f32_16x16x32_bf16 v[52:55], v[192:195], v[88:91], 0
    v_mfma_f32_16x16x32_bf16 v[148:151], v[208:211], v[88:91], 0
    s_waitcnt lgkmcnt(6)
    v_mfma_f32_16x16x32_bf16 v[52:55], v[196:199], v[184:187], v[52:55]
    v_mfma_f32_16x16x32_bf16 v[148:151], v[212:215], v[184:187], v[148:151]
    s_waitcnt lgkmcnt(5)
    v_mfma_f32_16x16x32_bf16 v[52:55], v[200:203], v[92:95], v[52:55]
    v_mfma_f32_16x16x32_bf16 v[148:151], v[216:219], v[92:95], v[148:151]
    s_waitcnt lgkmcnt(4)
    v_mfma_f32_16x16x32_bf16 v[52:55], v[204:207], v[188:191], v[52:55]
    v_mfma_f32_16x16x32_bf16 v[148:151], v[220:223], v[188:191], v[148:151]
    ds_read_b128 v[88:91], v255 offset:12288
    ds_read_b128 v[184:187], v255 offset:13312
    ds_read_b128 v[92:95], v255 offset:14336
    ds_read_b128 v[188:191], v255 offset:15360
    s_waitcnt lgkmcnt(7)
    v_mfma_f32_16x16x32_bf16 v[56:59], v[192:195], v[224:227], 0
    v_mfma_f32_16x16x32_bf16 v[152:155], v[208:211], v[224:227], 0
    s_waitcnt lgkmcnt(6)
    v_mfma_f32_16x16x32_bf16 v[56:59], v[196:199], v[228:231], v[56:59]
    v_mfma_f32_16x16x32_bf16 v[152:155], v[212:215], v[228:231], v[152:155]
    s_waitcnt lgkmcnt(5)
    v_mfma_f32_16x16x32_bf16 v[56:59], v[200:203], v[232:235], v[56:59]
    v_mfma_f32_16x16x32_bf16 v[152:155], v[216:219], v[232:235], v[152:155]
    s_waitcnt lgkmcnt(4)
    v_mfma_f32_16x16x32_bf16 v[56:59], v[204:207], v[236:239], v[56:59]
    v_mfma_f32_16x16x32_bf16 v[152:155], v[220:223], v[236:239], v[152:155]
    ds_read_b128 v[224:227], v255 offset:16384
    ds_read_b128 v[228:231], v255 offset:17408
    ds_read_b128 v[232:235], v255 offset:18432
    ds_read_b128 v[236:239], v255 offset:19456
    s_waitcnt lgkmcnt(7)
    v_mfma_f32_16x16x32_bf16 v[60:63], v[192:195], v[88:91], 0
    v_mfma_f32_16x16x32_bf16 v[156:159], v[208:211], v[88:91], 0
    s_waitcnt lgkmcnt(6)
    v_mfma_f32_16x16x32_bf16 v[60:63], v[196:199], v[184:187], v[60:63]
    v_mfma_f32_16x16x32_bf16 v[156:159], v[212:215], v[184:187], v[156:159]
    s_waitcnt lgkmcnt(5)
    v_mfma_f32_16x16x32_bf16 v[60:63], v[200:203], v[92:95], v[60:63]
    v_mfma_f32_16x16x32_bf16 v[156:159], v[216:219], v[92:95], v[156:159]
    s_waitcnt lgkmcnt(4)
    v_mfma_f32_16x16x32_bf16 v[60:63], v[204:207], v[188:191], v[60:63]
    v_mfma_f32_16x16x32_bf16 v[156:159], v[220:223], v[188:191], v[156:159]
    ds_read_b128 v[88:91], v255 offset:20480
    ds_read_b128 v[184:187], v255 offset:21504
    ds_read_b128 v[92:95], v255 offset:22528
    ds_read_b128 v[188:191], v255 offset:23552
    s_waitcnt lgkmcnt(7)
    v_mfma_f32_16x16x32_bf16 v[64:67], v[192:195], v[224:227], 0
    v_mfma_f32_16x16x32_bf16 v[160:163], v[208:211], v[224:227], 0
    s_waitcnt lgkmcnt(6)
    v_mfma_f32_16x16x32_bf16 v[64:67], v[196:199], v[228:231], v[64:67]
    v_mfma_f32_16x16x32_bf16 v[160:163], v[212:215], v[228:231], v[160:163]
    s_waitcnt lgkmcnt(5)
    v_mfma_f32_16x16x32_bf16 v[64:67], v[200:203], v[232:235], v[64:67]
    v_mfma_f32_16x16x32_bf16 v[160:163], v[216:219], v[232:235], v[160:163]
    s_waitcnt lgkmcnt(4)
    v_mfma_f32_16x16x32_bf16 v[64:67], v[204:207], v[236:239], v[64:67]
    v_mfma_f32_16x16x32_bf16 v[160:163], v[220:223], v[236:239], v[160:163]
    ds_read_b128 v[224:227], v255 offset:0
    ds_read_b128 v[228:231], v255 offset:1024
    ds_read_b128 v[232:235], v255 offset:2048
    ds_read_b128 v[236:239], v255 offset:3072
    s_waitcnt lgkmcnt(7)
    v_mfma_f32_16x16x32_bf16 v[68:71], v[192:195], v[88:91], 0
    v_mfma_f32_16x16x32_bf16 v[164:167], v[208:211], v[88:91], 0
    s_waitcnt lgkmcnt(6)
    v_mfma_f32_16x16x32_bf16 v[68:71], v[196:199], v[184:187], v[68:71]
    v_mfma_f32_16x16x32_bf16 v[164:167], v[212:215], v[184:187], v[164:167]
    s_waitcnt lgkmcnt(5)
    v_mfma_f32_16x16x32_bf16 v[68:71], v[200:203], v[92:95], v[68:71]
    v_mfma_f32_16x16x32_bf16 v[164:167], v[216:219], v[92:95], v[164:167]
    s_waitcnt lgkmcnt(4)
    v_mfma_f32_16x16x32_bf16 v[68:71], v[204:207], v[188:191], v[68:71]
    v_mfma_f32_16x16x32_bf16 v[164:167], v[220:223], v[188:191], v[164:167]
    s_barrier
    ds_read_b128 v[192:195], v248 offset:49152
    ds_read_b128 v[208:211], v244 offset:0
    ds_read_b128 v[196:199], v249 offset:49152
    ds_read_b128 v[212:215], v245 offset:0
    ds_read_b128 v[200:203], v250 offset:49152
    ds_read_b128 v[216:219], v246 offset:0
    ds_read_b128 v[204:207], v251 offset:49152
    ds_read_b128 v[220:223], v247 offset:0
    ds_read_b128 v[88:91], v255 offset:4096
    ds_read_b128 v[184:187], v255 offset:5120
    ds_read_b128 v[92:95], v255 offset:6144
    ds_read_b128 v[188:191], v255 offset:7168
    s_waitcnt lgkmcnt(10)
    v_mfma_f32_16x16x32_bf16 v[72:75], v[192:195], v[224:227], 0
    v_mfma_f32_16x16x32_bf16 v[168:171], v[208:211], v[224:227], 0
    s_waitcnt lgkmcnt(8)
    v_mfma_f32_16x16x32_bf16 v[72:75], v[196:199], v[228:231], v[72:75]
    v_mfma_f32_16x16x32_bf16 v[168:171], v[212:215], v[228:231], v[168:171]
    s_waitcnt lgkmcnt(6)
    v_mfma_f32_16x16x32_bf16 v[72:75], v[200:203], v[232:235], v[72:75]
    v_mfma_f32_16x16x32_bf16 v[168:171], v[216:219], v[232:235], v[168:171]
    s_waitcnt lgkmcnt(4)
    v_mfma_f32_16x16x32_bf16 v[72:75], v[204:207], v[236:239], v[72:75]
    v_mfma_f32_16x16x32_bf16 v[168:171], v[220:223], v[236:239], v[168:171]
    ds_read_b128 v[224:227], v255 offset:8192
    ds_read_b128 v[228:231], v255 offset:9216
    ds_read_b128 v[232:235], v255 offset:10240
    ds_read_b128 v[236:239], v255 offset:11264
    s_waitcnt lgkmcnt(7)
    v_mfma_f32_16x16x32_bf16 v[76:79], v[192:195], v[88:91], 0
    v_mfma_f32_16x16x32_bf16 v[172:175], v[208:211], v[88:91], 0
    s_waitcnt lgkmcnt(6)
    v_mfma_f32_16x16x32_bf16 v[76:79], v[196:199], v[184:187], v[76:79]
    v_mfma_f32_16x16x32_bf16 v[172:175], v[212:215], v[184:187], v[172:175]
    s_waitcnt lgkmcnt(5)
    v_mfma_f32_16x16x32_bf16 v[76:79], v[200:203], v[92:95], v[76:79]
    v_mfma_f32_16x16x32_bf16 v[172:175], v[216:219], v[92:95], v[172:175]
    s_waitcnt lgkmcnt(4)
    v_mfma_f32_16x16x32_bf16 v[76:79], v[204:207], v[188:191], v[76:79]
    v_mfma_f32_16x16x32_bf16 v[172:175], v[220:223], v[188:191], v[172:175]
    ds_read_b128 v[88:91], v255 offset:12288
    ds_read_b128 v[184:187], v255 offset:13312
    ds_read_b128 v[92:95], v255 offset:14336
    ds_read_b128 v[188:191], v255 offset:15360
    s_waitcnt lgkmcnt(7)
    v_mfma_f32_16x16x32_bf16 v[80:83], v[192:195], v[224:227], 0
    v_mfma_f32_16x16x32_bf16 v[176:179], v[208:211], v[224:227], 0
    s_waitcnt lgkmcnt(6)
    v_mfma_f32_16x16x32_bf16 v[80:83], v[196:199], v[228:231], v[80:83]
    v_mfma_f32_16x16x32_bf16 v[176:179], v[212:215], v[228:231], v[176:179]
    s_waitcnt lgkmcnt(5)
    v_mfma_f32_16x16x32_bf16 v[80:83], v[200:203], v[232:235], v[80:83]
    v_mfma_f32_16x16x32_bf16 v[176:179], v[216:219], v[232:235], v[176:179]
    s_waitcnt lgkmcnt(4)
    v_mfma_f32_16x16x32_bf16 v[80:83], v[204:207], v[236:239], v[80:83]
    v_mfma_f32_16x16x32_bf16 v[176:179], v[220:223], v[236:239], v[176:179]
    ds_read_b128 v[224:227], v255 offset:16384
    ds_read_b128 v[228:231], v255 offset:17408
    ds_read_b128 v[232:235], v255 offset:18432
    ds_read_b128 v[236:239], v255 offset:19456
    s_waitcnt lgkmcnt(7)
    v_mfma_f32_16x16x32_bf16 v[84:87], v[192:195], v[88:91], 0
    v_mfma_f32_16x16x32_bf16 v[180:183], v[208:211], v[88:91], 0
    s_waitcnt lgkmcnt(6)
    v_mfma_f32_16x16x32_bf16 v[84:87], v[196:199], v[184:187], v[84:87]
    v_mfma_f32_16x16x32_bf16 v[180:183], v[212:215], v[184:187], v[180:183]
    s_waitcnt lgkmcnt(5)
    v_mfma_f32_16x16x32_bf16 v[84:87], v[200:203], v[92:95], v[84:87]
    v_mfma_f32_16x16x32_bf16 v[180:183], v[216:219], v[92:95], v[180:183]
    s_waitcnt lgkmcnt(4)
    v_mfma_f32_16x16x32_bf16 v[84:87], v[204:207], v[188:191], v[84:87]
    v_mfma_f32_16x16x32_bf16 v[180:183], v[220:223], v[188:191], v[180:183]
    s_waitcnt lgkmcnt(3)
    v_mfma_f32_16x16x32_bf16 v[88:91], v[192:195], v[224:227], 0
    v_mfma_f32_16x16x32_bf16 v[184:187], v[208:211], v[224:227], 0
    ds_read_b128 v[224:227], v255 offset:20480
    s_waitcnt lgkmcnt(3)
    v_mfma_f32_16x16x32_bf16 v[88:91], v[196:199], v[228:231], v[88:91]
    v_mfma_f32_16x16x32_bf16 v[184:187], v[212:215], v[228:231], v[184:187]
    ds_read_b128 v[228:231], v255 offset:21504
    s_waitcnt lgkmcnt(3)
    v_mfma_f32_16x16x32_bf16 v[88:91], v[200:203], v[232:235], v[88:91]
    v_mfma_f32_16x16x32_bf16 v[184:187], v[216:219], v[232:235], v[184:187]
    ds_read_b128 v[232:235], v255 offset:22528
    s_waitcnt lgkmcnt(3)
    v_mfma_f32_16x16x32_bf16 v[88:91], v[204:207], v[236:239], v[88:91]
    v_mfma_f32_16x16x32_bf16 v[184:187], v[220:223], v[236:239], v[184:187]
    ds_read_b128 v[236:239], v255 offset:23552
    s_waitcnt lgkmcnt(3)
    v_mfma_f32_16x16x32_bf16 v[92:95], v[192:195], v[224:227], 0
    v_mfma_f32_16x16x32_bf16 v[188:191], v[208:211], v[224:227], 0
    s_waitcnt lgkmcnt(2)
    v_mfma_f32_16x16x32_bf16 v[92:95], v[196:199], v[228:231], v[92:95]
    v_mfma_f32_16x16x32_bf16 v[188:191], v[212:215], v[228:231], v[188:191]
    s_waitcnt lgkmcnt(1)
    v_mfma_f32_16x16x32_bf16 v[92:95], v[200:203], v[232:235], v[92:95]
    v_mfma_f32_16x16x32_bf16 v[188:191], v[216:219], v[232:235], v[188:191]
    s_waitcnt lgkmcnt(0)
    v_mfma_f32_16x16x32_bf16 v[92:95], v[204:207], v[236:239], v[92:95]
    v_mfma_f32_16x16x32_bf16 v[188:191], v[220:223], v[236:239], v[188:191]
    s_nop 7
    s_mov_b32 s50, 0x3e0293ee
    s_mov_b32 s51, 0x3e0293ee
    v_max3_f32 v224, v0, v1, v2
    v_max3_f32 v225, v3, v96, v97
    v_max3_f32 v224, v224, v98, v99
    v_max3_f32 v225, v225, v24, v25
    v_max3_f32 v224, v224, v26, v27
    v_max3_f32 v225, v225, v120, v121
    v_max3_f32 v224, v224, v122, v123
    v_max3_f32 v225, v225, v48, v49
    v_max3_f32 v224, v224, v50, v51
    v_max3_f32 v225, v225, v144, v145
    v_max3_f32 v224, v224, v146, v147
    v_max3_f32 v225, v225, v72, v73
    v_max3_f32 v224, v224, v74, v75
    v_max3_f32 v225, v225, v168, v169
    v_max3_f32 v224, v224, v170, v171
    v_max_f32 v224, v224, v225
    v_mov_b32 v225, v224
    v_max3_f32 v226, v4, v5, v6
    v_max3_f32 v227, v7, v100, v101
    v_max3_f32 v226, v226, v102, v103
    v_max3_f32 v227, v227, v28, v29
    v_max3_f32 v226, v226, v30, v31
    v_max3_f32 v227, v227, v124, v125
    v_max3_f32 v226, v226, v126, v127
    v_max3_f32 v227, v227, v52, v53
    v_max3_f32 v226, v226, v54, v55
    v_max3_f32 v227, v227, v148, v149
    v_max3_f32 v226, v226, v150, v151
    v_max3_f32 v227, v227, v76, v77
    v_max3_f32 v226, v226, v78, v79
    v_max3_f32 v227, v227, v172, v173
    v_max3_f32 v226, v226, v174, v175
    v_max_f32 v226, v226, v227
    v_mov_b32 v227, v226
    v_max3_f32 v228, v8, v9, v10
    v_max3_f32 v229, v11, v104, v105
    v_max3_f32 v228, v228, v106, v107
    v_max3_f32 v229, v229, v32, v33
    v_max3_f32 v228, v228, v34, v35
    v_max3_f32 v229, v229, v128, v129
    v_max3_f32 v228, v228, v130, v131
    v_max3_f32 v229, v229, v56, v57
    v_max3_f32 v228, v228, v58, v59
    v_max3_f32 v229, v229, v152, v153
    v_max3_f32 v228, v228, v154, v155
    v_max3_f32 v229, v229, v80, v81
    v_max3_f32 v228, v228, v82, v83
    v_max3_f32 v229, v229, v176, v177
    v_max3_f32 v228, v228, v178, v179
    v_max_f32 v228, v228, v229
    v_mov_b32 v229, v228
    v_max3_f32 v230, v12, v13, v14
    v_max3_f32 v231, v15, v108, v109
    v_max3_f32 v230, v230, v110, v111
    v_max3_f32 v231, v231, v36, v37
    v_max3_f32 v230, v230, v38, v39
    v_max3_f32 v231, v231, v132, v133
    v_max3_f32 v230, v230, v134, v135
    v_max3_f32 v231, v231, v60, v61
    v_max3_f32 v230, v230, v62, v63
    v_max3_f32 v231, v231, v156, v157
    v_max3_f32 v230, v230, v158, v159
    v_max3_f32 v231, v231, v84, v85
    v_max3_f32 v230, v230, v86, v87
    v_max3_f32 v231, v231, v180, v181
    v_max3_f32 v230, v230, v182, v183
    v_max_f32 v230, v230, v231
    v_mov_b32 v231, v230
    v_max3_f32 v232, v16, v17, v18
    v_max3_f32 v233, v19, v112, v113
    v_max3_f32 v232, v232, v114, v115
    v_max3_f32 v233, v233, v40, v41
    v_max3_f32 v232, v232, v42, v43
    v_max3_f32 v233, v233, v136, v137
    v_max3_f32 v232, v232, v138, v139
    v_max3_f32 v233, v233, v64, v65
    v_max3_f32 v232, v232, v66, v67
    v_max3_f32 v233, v233, v160, v161
    v_max3_f32 v232, v232, v162, v163
    v_max3_f32 v233, v233, v88, v89
    v_max3_f32 v232, v232, v90, v91
    v_max3_f32 v233, v233, v184, v185
    v_max3_f32 v232, v232, v186, v187
    v_max_f32 v232, v232, v233
    v_mov_b32 v233, v232
    v_max3_f32 v234, v20, v21, v22
    v_max3_f32 v235, v23, v116, v117
    v_max3_f32 v234, v234, v118, v119
    v_max3_f32 v235, v235, v44, v45
    v_max3_f32 v234, v234, v46, v47
    v_max3_f32 v235, v235, v140, v141
    v_max3_f32 v234, v234, v142, v143
    v_max3_f32 v235, v235, v68, v69
    v_max3_f32 v234, v234, v70, v71
    v_max3_f32 v235, v235, v164, v165
    v_max3_f32 v234, v234, v166, v167
    v_max3_f32 v235, v235, v92, v93
    v_max3_f32 v234, v234, v94, v95
    v_max3_f32 v235, v235, v188, v189
    v_max3_f32 v234, v234, v190, v191
    v_max_f32 v234, v234, v235
    v_mov_b32 v235, v234
    s_nop 1
    v_permlane32_swap_b32 v224, v225
    v_permlane32_swap_b32 v226, v227
    v_permlane32_swap_b32 v228, v229
    v_permlane32_swap_b32 v230, v231
    v_permlane32_swap_b32 v232, v233
    v_permlane32_swap_b32 v234, v235
    v_max_f32 v224, v224, v225
    v_max_f32 v226, v226, v227
    v_max_f32 v228, v228, v229
    v_max_f32 v230, v230, v231
    v_max_f32 v232, v232, v233
    v_max_f32 v234, v234, v235
    v_mov_b32 v225, v224
    v_mov_b32 v227, v226
    v_mov_b32 v229, v228
    v_mov_b32 v231, v230
    v_mov_b32 v233, v232
    v_mov_b32 v235, v234
    s_nop 1
    v_permlane16_swap_b32 v224, v225
    v_permlane16_swap_b32 v226, v227
    v_permlane16_swap_b32 v228, v229
    v_permlane16_swap_b32 v230, v231
    v_permlane16_swap_b32 v232, v233
    v_permlane16_swap_b32 v234, v235
    v_max_f32 v224, v224, v225
    v_max_f32 v226, v226, v227
    v_max_f32 v228, v228, v229
    v_max_f32 v230, v230, v231
    v_max_f32 v232, v232, v233
    v_max_f32 v234, v234, v235
    ds_write_b32 v254, v224 offset:0
    ds_write_b32 v254, v226 offset:256
    ds_write_b32 v254, v228 offset:512
    ds_write_b32 v254, v230 offset:768
    ds_write_b32 v254, v232 offset:1024
    ds_write_b32 v254, v234 offset:1280
    s_mul_i32 s59, s46, 24576
    v_add_u32 v252, s59, v255
    v_add_u32 v237, 49152, v255
    v_and_b32 v245, 0xf0, v255
    v_lshlrev_b32 v245, 1, v245
    v_add_u32 v239, s59, v245
    v_add_u32 v247, 49152, v245
    s_waitcnt lgkmcnt(0)
    s_barrier
    ds_read_b128 v[196:199], v253 offset:0
    ds_read_b128 v[200:203], v253 offset:256
    ds_read_b128 v[204:207], v253 offset:512
    ds_read_b128 v[208:211], v253 offset:768
    ds_read_b128 v[212:215], v253 offset:1024
    ds_read_b128 v[216:219], v253 offset:1280
    s_waitcnt lgkmcnt(5)
    v_max3_f32 v196, v196, v197, v198
    v_max_f32 v196, v196, v199
    v_mul_f32 v236, s50, v196
    s_waitcnt lgkmcnt(4)
    v_max3_f32 v200, v200, v201, v202
    v_max_f32 v200, v200, v203
    v_mul_f32 v238, s50, v200
    s_waitcnt lgkmcnt(3)
    v_max3_f32 v204, v204, v205, v206
    v_max_f32 v204, v204, v207
    v_mul_f32 v240, s50, v204
    s_waitcnt lgkmcnt(2)
    v_max3_f32 v208, v208, v209, v210
    v_max_f32 v208, v208, v211
    v_mul_f32 v244, s50, v208
    s_waitcnt lgkmcnt(1)
    v_max3_f32 v212, v212, v213, v214
    v_max_f32 v212, v212, v215
    v_mul_f32 v246, s50, v212
    s_waitcnt lgkmcnt(0)
    v_max3_f32 v216, v216, v217, v218
    v_max_f32 v216, v216, v219
    v_mul_f32 v248, s50, v216
    v_mov_b32 v192, 0x3f803f80
    v_mov_b32 v193, 0x3f803f80
    v_mov_b32 v194, 0x3f803f80
    v_mov_b32 v195, 0x3f803f80
    v_pk_fma_f32 v[0:1], v[0:1], s[50:51], v[236:237] op_sel_hi:[1,1,0] neg_lo:[0,0,1] neg_hi:[0,0,1]
    v_pk_fma_f32 v[2:3], v[2:3], s[50:51], v[236:237] op_sel_hi:[1,1,0] neg_lo:[0,0,1] neg_hi:[0,0,1]
    v_pk_fma_f32 v[96:97], v[96:97], s[50:51], v[236:237] op_sel_hi:[1,1,0] neg_lo:[0,0,1] neg_hi:[0,0,1]
    v_pk_fma_f32 v[98:99], v[98:99], s[50:51], v[236:237] op_sel_hi:[1,1,0] neg_lo:[0,0,1] neg_hi:[0,0,1]
    v_exp_f32 v0, v0
    v_exp_f32 v1, v1
    v_exp_f32 v2, v2
    v_exp_f32 v3, v3
    v_exp_f32 v96, v96
    v_exp_f32 v97, v97
    v_exp_f32 v98, v98
    v_exp_f32 v99, v99
    v_cvt_pk_bf16_f32 v0, v0, v1
    v_cvt_pk_bf16_f32 v1, v2, v3
    v_cvt_pk_bf16_f32 v2, v96, v97
    v_cvt_pk_bf16_f32 v3, v98, v99
    ds_write_b128 v252, v[0:3] offset:0
    v_pk_fma_f32 v[4:5], v[4:5], s[50:51], v[238:239] op_sel_hi:[1,1,0] neg_lo:[0,0,1] neg_hi:[0,0,1]
    v_pk_fma_f32 v[6:7], v[6:7], s[50:51], v[238:239] op_sel_hi:[1,1,0] neg_lo:[0,0,1] neg_hi:[0,0,1]
    v_pk_fma_f32 v[100:101], v[100:101], s[50:51], v[238:239] op_sel_hi:[1,1,0] neg_lo:[0,0,1] neg_hi:[0,0,1]
    v_pk_fma_f32 v[102:103], v[102:103], s[50:51], v[238:239] op_sel_hi:[1,1,0] neg_lo:[0,0,1] neg_hi:[0,0,1]
    v_mfma_f32_16x16x32_bf16 v[196:199], v[192:195], v[0:3], 0
    v_exp_f32 v4, v4
    v_exp_f32 v5, v5
    v_exp_f32 v6, v6
    v_exp_f32 v7, v7
    v_exp_f32 v100, v100
    v_exp_f32 v101, v101
    v_exp_f32 v102, v102
    v_exp_f32 v103, v103
    v_cvt_pk_bf16_f32 v4, v4, v5
    v_cvt_pk_bf16_f32 v5, v6, v7
    v_cvt_pk_bf16_f32 v6, v100, v101
    v_cvt_pk_bf16_f32 v7, v102, v103
    ds_write_b128 v252, v[4:7] offset:4096
    v_pk_fma_f32 v[8:9], v[8:9], s[50:51], v[240:241] op_sel_hi:[1,1,0] neg_lo:[0,0,1] neg_hi:[0,0,1]
    v_pk_fma_f32 v[10:11], v[10:11], s[50:51], v[240:241] op_sel_hi:[1,1,0] neg_lo:[0,0,1] neg_hi:[0,0,1]
    v_pk_fma_f32 v[104:105], v[104:105], s[50:51], v[240:241] op_sel_hi:[1,1,0] neg_lo:[0,0,1] neg_hi:[0,0,1]
    v_pk_fma_f32 v[106:107], v[106:107], s[50:51], v[240:241] op_sel_hi:[1,1,0] neg_lo:[0,0,1] neg_hi:[0,0,1]
    v_mfma_f32_16x16x32_bf16 v[200:203], v[192:195], v[4:7], 0
    v_exp_f32 v8, v8
    v_exp_f32 v9, v9
    v_exp_f32 v10, v10
    v_exp_f32 v11, v11
    v_exp_f32 v104, v104
    v_exp_f32 v105, v105
    v_exp_f32 v106, v106
    v_exp_f32 v107, v107
    v_cvt_pk_bf16_f32 v8, v8, v9
    v_cvt_pk_bf16_f32 v9, v10, v11
    v_cvt_pk_bf16_f32 v10, v104, v105
    v_cvt_pk_bf16_f32 v11, v106, v107
    ds_write_b128 v252, v[8:11] offset:8192
    v_pk_fma_f32 v[12:13], v[12:13], s[50:51], v[244:245] op_sel_hi:[1,1,0] neg_lo:[0,0,1] neg_hi:[0,0,1]
    v_pk_fma_f32 v[14:15], v[14:15], s[50:51], v[244:245] op_sel_hi:[1,1,0] neg_lo:[0,0,1] neg_hi:[0,0,1]
    v_pk_fma_f32 v[108:109], v[108:109], s[50:51], v[244:245] op_sel_hi:[1,1,0] neg_lo:[0,0,1] neg_hi:[0,0,1]
    v_pk_fma_f32 v[110:111], v[110:111], s[50:51], v[244:245] op_sel_hi:[1,1,0] neg_lo:[0,0,1] neg_hi:[0,0,1]
    v_mfma_f32_16x16x32_bf16 v[204:207], v[192:195], v[8:11], 0
    v_exp_f32 v12, v12
    v_exp_f32 v13, v13
    v_exp_f32 v14, v14
    v_exp_f32 v15, v15
    v_exp_f32 v108, v108
    v_exp_f32 v109, v109
    v_exp_f32 v110, v110
    v_exp_f32 v111, v111
    v_cvt_pk_bf16_f32 v12, v12, v13
    v_cvt_pk_bf16_f32 v13, v14, v15
    v_cvt_pk_bf16_f32 v14, v108, v109
    v_cvt_pk_bf16_f32 v15, v110, v111
    ds_write_b128 v252, v[12:15] offset:12288
    v_pk_fma_f32 v[16:17], v[16:17], s[50:51], v[246:247] op_sel_hi:[1,1,0] neg_lo:[0,0,1] neg_hi:[0,0,1]
    v_pk_fma_f32 v[18:19], v[18:19], s[50:51], v[246:247] op_sel_hi:[1,1,0] neg_lo:[0,0,1] neg_hi:[0,0,1]
    v_pk_fma_f32 v[112:113], v[112:113], s[50:51], v[246:247] op_sel_hi:[1,1,0] neg_lo:[0,0,1] neg_hi:[0,0,1]
    v_pk_fma_f32 v[114:115], v[114:115], s[50:51], v[246:247] op_sel_hi:[1,1,0] neg_lo:[0,0,1] neg_hi:[0,0,1]
    v_mfma_f32_16x16x32_bf16 v[208:211], v[192:195], v[12:15], 0
    v_exp_f32 v16, v16
    v_exp_f32 v17, v17
    v_exp_f32 v18, v18
    v_exp_f32 v19, v19
    v_exp_f32 v112, v112
    v_exp_f32 v113, v113
    v_exp_f32 v114, v114
    v_exp_f32 v115, v115
    v_cvt_pk_bf16_f32 v16, v16, v17
    v_cvt_pk_bf16_f32 v17, v18, v19
    v_cvt_pk_bf16_f32 v18, v112, v113
    v_cvt_pk_bf16_f32 v19, v114, v115
    ds_write_b128 v252, v[16:19] offset:16384
    v_pk_fma_f32 v[20:21], v[20:21], s[50:51], v[248:249] op_sel_hi:[1,1,0] neg_lo:[0,0,1] neg_hi:[0,0,1]
    v_pk_fma_f32 v[22:23], v[22:23], s[50:51], v[248:249] op_sel_hi:[1,1,0] neg_lo:[0,0,1] neg_hi:[0,0,1]
    v_pk_fma_f32 v[116:117], v[116:117], s[50:51], v[248:249] op_sel_hi:[1,1,0] neg_lo:[0,0,1] neg_hi:[0,0,1]
    v_pk_fma_f32 v[118:119], v[118:119], s[50:51], v[248:249] op_sel_hi:[1,1,0] neg_lo:[0,0,1] neg_hi:[0,0,1]
    v_mfma_f32_16x16x32_bf16 v[212:215], v[192:195], v[16:19], 0
    v_exp_f32 v20, v20
    v_exp_f32 v21, v21
    v_exp_f32 v22, v22
    v_exp_f32 v23, v23
    v_exp_f32 v116, v116
    v_exp_f32 v117, v117
    v_exp_f32 v118, v118
    v_exp_f32 v119, v119
    v_cvt_pk_bf16_f32 v20, v20, v21
    v_cvt_pk_bf16_f32 v21, v22, v23
    v_cvt_pk_bf16_f32 v22, v116, v117
    v_cvt_pk_bf16_f32 v23, v118, v119
    ds_write_b128 v252, v[20:23] offset:20480
    s_nop 1
    v_mfma_f32_16x16x32_bf16 v[216:219], v[192:195], v[20:23], 0
    v_pk_fma_f32 v[24:25], v[24:25], s[50:51], v[236:237] op_sel_hi:[1,1,0] neg_lo:[0,0,1] neg_hi:[0,0,1]
    v_pk_fma_f32 v[26:27], v[26:27], s[50:51], v[236:237] op_sel_hi:[1,1,0] neg_lo:[0,0,1] neg_hi:[0,0,1]
    v_pk_fma_f32 v[120:121], v[120:121], s[50:51], v[236:237] op_sel_hi:[1,1,0] neg_lo:[0,0,1] neg_hi:[0,0,1]
    v_pk_fma_f32 v[122:123], v[122:123], s[50:51], v[236:237] op_sel_hi:[1,1,0] neg_lo:[0,0,1] neg_hi:[0,0,1]
    v_exp_f32 v24, v24
    v_exp_f32 v25, v25
    v_exp_f32 v26, v26
    v_exp_f32 v27, v27
    v_exp_f32 v120, v120
    v_exp_f32 v121, v121
    v_exp_f32 v122, v122
    v_exp_f32 v123, v123
    v_cvt_pk_bf16_f32 v24, v24, v25
    v_cvt_pk_bf16_f32 v25, v26, v27
    v_cvt_pk_bf16_f32 v26, v120, v121
    v_cvt_pk_bf16_f32 v27, v122, v123
    ds_write_b128 v252, v[24:27] offset:1024
    v_pk_fma_f32 v[28:29], v[28:29], s[50:51], v[238:239] op_sel_hi:[1,1,0] neg_lo:[0,0,1] neg_hi:[0,0,1]
    v_pk_fma_f32 v[30:31], v[30:31], s[50:51], v[238:239] op_sel_hi:[1,1,0] neg_lo:[0,0,1] neg_hi:[0,0,1]
    v_pk_fma_f32 v[124:125], v[124:125], s[50:51], v[238:239] op_sel_hi:[1,1,0] neg_lo:[0,0,1] neg_hi:[0,0,1]
    v_pk_fma_f32 v[126:127], v[126:127], s[50:51], v[238:239] op_sel_hi:[1,1,0] neg_lo:[0,0,1] neg_hi:[0,0,1]
    v_mfma_f32_16x16x32_bf16 v[196:199], v[192:195], v[24:27], v[196:199]
    v_exp_f32 v28, v28
    v_exp_f32 v29, v29
    v_exp_f32 v30, v30
    v_exp_f32 v31, v31
    v_exp_f32 v124, v124
    v_exp_f32 v125, v125
    v_exp_f32 v126, v126
    v_exp_f32 v127, v127
    v_cvt_pk_bf16_f32 v28, v28, v29
    v_cvt_pk_bf16_f32 v29, v30, v31
    v_cvt_pk_bf16_f32 v30, v124, v125
    v_cvt_pk_bf16_f32 v31, v126, v127
    ds_write_b128 v252, v[28:31] offset:5120
    v_pk_fma_f32 v[32:33], v[32:33], s[50:51], v[240:241] op_sel_hi:[1,1,0] neg_lo:[0,0,1] neg_hi:[0,0,1]
    v_pk_fma_f32 v[34:35], v[34:35], s[50:51], v[240:241] op_sel_hi:[1,1,0] neg_lo:[0,0,1] neg_hi:[0,0,1]
    v_pk_fma_f32 v[128:129], v[128:129], s[50:51], v[240:241] op_sel_hi:[1,1,0] neg_lo:[0,0,1] neg_hi:[0,0,1]
    v_pk_fma_f32 v[130:131], v[130:131], s[50:51], v[240:241] op_sel_hi:[1,1,0] neg_lo:[0,0,1] neg_hi:[0,0,1]
    v_mfma_f32_16x16x32_bf16 v[200:203], v[192:195], v[28:31], v[200:203]
    v_exp_f32 v32, v32
    v_exp_f32 v33, v33
    v_exp_f32 v34, v34
    v_exp_f32 v35, v35
    v_exp_f32 v128, v128
    v_exp_f32 v129, v129
    v_exp_f32 v130, v130
    v_exp_f32 v131, v131
    v_cvt_pk_bf16_f32 v32, v32, v33
    v_cvt_pk_bf16_f32 v33, v34, v35
    v_cvt_pk_bf16_f32 v34, v128, v129
    v_cvt_pk_bf16_f32 v35, v130, v131
    ds_write_b128 v252, v[32:35] offset:9216
    v_pk_fma_f32 v[36:37], v[36:37], s[50:51], v[244:245] op_sel_hi:[1,1,0] neg_lo:[0,0,1] neg_hi:[0,0,1]
    v_pk_fma_f32 v[38:39], v[38:39], s[50:51], v[244:245] op_sel_hi:[1,1,0] neg_lo:[0,0,1] neg_hi:[0,0,1]
    v_pk_fma_f32 v[132:133], v[132:133], s[50:51], v[244:245] op_sel_hi:[1,1,0] neg_lo:[0,0,1] neg_hi:[0,0,1]
    v_pk_fma_f32 v[134:135], v[134:135], s[50:51], v[244:245] op_sel_hi:[1,1,0] neg_lo:[0,0,1] neg_hi:[0,0,1]
    v_mfma_f32_16x16x32_bf16 v[204:207], v[192:195], v[32:35], v[204:207]
    v_exp_f32 v36, v36
    v_exp_f32 v37, v37
    v_exp_f32 v38, v38
    v_exp_f32 v39, v39
    v_exp_f32 v132, v132
    v_exp_f32 v133, v133
    v_exp_f32 v134, v134
    v_exp_f32 v135, v135
    v_cvt_pk_bf16_f32 v36, v36, v37
    v_cvt_pk_bf16_f32 v37, v38, v39
    v_cvt_pk_bf16_f32 v38, v132, v133
    v_cvt_pk_bf16_f32 v39, v134, v135
    ds_write_b128 v252, v[36:39] offset:13312
    v_pk_fma_f32 v[40:41], v[40:41], s[50:51], v[246:247] op_sel_hi:[1,1,0] neg_lo:[0,0,1] neg_hi:[0,0,1]
    v_pk_fma_f32 v[42:43], v[42:43], s[50:51], v[246:247] op_sel_hi:[1,1,0] neg_lo:[0,0,1] neg_hi:[0,0,1]
    v_pk_fma_f32 v[136:137], v[136:137], s[50:51], v[246:247] op_sel_hi:[1,1,0] neg_lo:[0,0,1] neg_hi:[0,0,1]
    v_pk_fma_f32 v[138:139], v[138:139], s[50:51], v[246:247] op_sel_hi:[1,1,0] neg_lo:[0,0,1] neg_hi:[0,0,1]
    v_mfma_f32_16x16x32_bf16 v[208:211], v[192:195], v[36:39], v[208:211]
    v_exp_f32 v40, v40
    v_exp_f32 v41, v41
    v_exp_f32 v42, v42
    v_exp_f32 v43, v43
    v_exp_f32 v136, v136
    v_exp_f32 v137, v137
    v_exp_f32 v138, v138
    v_exp_f32 v139, v139
    v_cvt_pk_bf16_f32 v40, v40, v41
    v_cvt_pk_bf16_f32 v41, v42, v43
    v_cvt_pk_bf16_f32 v42, v136, v137
    v_cvt_pk_bf16_f32 v43, v138, v139
    ds_write_b128 v252, v[40:43] offset:17408
    v_pk_fma_f32 v[44:45], v[44:45], s[50:51], v[248:249] op_sel_hi:[1,1,0] neg_lo:[0,0,1] neg_hi:[0,0,1]
    v_pk_fma_f32 v[46:47], v[46:47], s[50:51], v[248:249] op_sel_hi:[1,1,0] neg_lo:[0,0,1] neg_hi:[0,0,1]
    v_pk_fma_f32 v[140:141], v[140:141], s[50:51], v[248:249] op_sel_hi:[1,1,0] neg_lo:[0,0,1] neg_hi:[0,0,1]
    v_pk_fma_f32 v[142:143], v[142:143], s[50:51], v[248:249] op_sel_hi:[1,1,0] neg_lo:[0,0,1] neg_hi:[0,0,1]
    v_mfma_f32_16x16x32_bf16 v[212:215], v[192:195], v[40:43], v[212:215]
    v_exp_f32 v44, v44
    v_exp_f32 v45, v45
    v_exp_f32 v46, v46
    v_exp_f32 v47, v47
    v_exp_f32 v140, v140
    v_exp_f32 v141, v141
    v_exp_f32 v142, v142
    v_exp_f32 v143, v143
    v_cvt_pk_bf16_f32 v44, v44, v45
    v_cvt_pk_bf16_f32 v45, v46, v47
    v_cvt_pk_bf16_f32 v46, v140, v141
    v_cvt_pk_bf16_f32 v47, v142, v143
    ds_write_b128 v252, v[44:47] offset:21504
    s_nop 1
    v_mfma_f32_16x16x32_bf16 v[216:219], v[192:195], v[44:47], v[216:219]
    s_waitcnt lgkmcnt(0)
    s_barrier
    ds_read_b64_tr_b16 v[220:221], v242 offset:0
    ds_read_b64_tr_b16 v[222:223], v242 offset:1024
    ds_read_b64_tr_b16 v[224:225], v243 offset:0
    ds_read_b64_tr_b16 v[226:227], v243 offset:1024
    ds_read_b128 v[24:27], v255 offset:0
    ds_read_b128 v[28:31], v255 offset:4096
    ds_read_b128 v[32:35], v255 offset:8192
    ds_read_b128 v[36:39], v255 offset:12288
    ds_read_b128 v[40:43], v255 offset:16384
    ds_read_b128 v[44:47], v255 offset:20480
    v_pk_fma_f32 v[48:49], v[48:49], s[50:51], v[236:237] op_sel_hi:[1,1,0] neg_lo:[0,0,1] neg_hi:[0,0,1]
    v_pk_fma_f32 v[50:51], v[50:51], s[50:51], v[236:237] op_sel_hi:[1,1,0] neg_lo:[0,0,1] neg_hi:[0,0,1]
    v_pk_fma_f32 v[144:145], v[144:145], s[50:51], v[236:237] op_sel_hi:[1,1,0] neg_lo:[0,0,1] neg_hi:[0,0,1]
    v_pk_fma_f32 v[146:147], v[146:147], s[50:51], v[236:237] op_sel_hi:[1,1,0] neg_lo:[0,0,1] neg_hi:[0,0,1]
    v_exp_f32 v48, v48
    v_exp_f32 v49, v49
    v_exp_f32 v50, v50
    v_exp_f32 v51, v51
    v_exp_f32 v144, v144
    v_exp_f32 v145, v145
    v_exp_f32 v146, v146
    v_exp_f32 v147, v147
    v_cvt_pk_bf16_f32 v48, v48, v49
    v_cvt_pk_bf16_f32 v49, v50, v51
    s_waitcnt lgkmcnt(0)
    v_mfma_f32_16x16x32_bf16 v[0:3], v[220:223], v[24:27], 0
    ds_read_b64_tr_b16 v[228:229], v242 offset:8192
    ds_read_b64_tr_b16 v[230:231], v242 offset:9216
    v_cvt_pk_bf16_f32 v50, v144, v145
    v_cvt_pk_bf16_f32 v51, v146, v147
    ds_write_b128 v252, v[48:51] offset:2048
    v_mfma_f32_16x16x32_bf16 v[4:7], v[224:227], v[24:27], 0
    ds_read_b64_tr_b16 v[232:233], v243 offset:8192
    ds_read_b64_tr_b16 v[234:235], v243 offset:9216
    v_pk_fma_f32 v[52:53], v[52:53], s[50:51], v[238:239] op_sel_hi:[1,1,0] neg_lo:[0,0,1] neg_hi:[0,0,1]
    v_pk_fma_f32 v[54:55], v[54:55], s[50:51], v[238:239] op_sel_hi:[1,1,0] neg_lo:[0,0,1] neg_hi:[0,0,1]
    v_pk_fma_f32 v[148:149], v[148:149], s[50:51], v[238:239] op_sel_hi:[1,1,0] neg_lo:[0,0,1] neg_hi:[0,0,1]
    v_mfma_f32_16x16x32_bf16 v[8:11], v[220:223], v[28:31], 0
    ds_read_b128 v[120:123], v255 offset:24576
    ds_read_b128 v[124:127], v255 offset:28672
    v_pk_fma_f32 v[150:151], v[150:151], s[50:51], v[238:239] op_sel_hi:[1,1,0] neg_lo:[0,0,1] neg_hi:[0,0,1]
    v_mfma_f32_16x16x32_bf16 v[196:199], v[192:195], v[48:51], v[196:199]
    v_exp_f32 v52, v52
    v_mfma_f32_16x16x32_bf16 v[12:15], v[224:227], v[28:31], 0
    ds_read_b128 v[128:131], v255 offset:32768
    ds_read_b128 v[132:135], v255 offset:36864
    v_exp_f32 v53, v53
    v_exp_f32 v54, v54
    v_exp_f32 v55, v55
    v_mfma_f32_16x16x32_bf16 v[16:19], v[220:223], v[32:35], 0
    ds_read_b128 v[136:139], v255 offset:40960
    ds_read_b128 v[140:143], v255 offset:45056
    v_exp_f32 v148, v148
    v_exp_f32 v149, v149
    v_exp_f32 v150, v150
    v_mfma_f32_16x16x32_bf16 v[20:23], v[224:227], v[32:35], 0
    v_exp_f32 v151, v151
    v_cvt_pk_bf16_f32 v52, v52, v53
    v_cvt_pk_bf16_f32 v53, v54, v55
    v_mfma_f32_16x16x32_bf16 v[96:99], v[220:223], v[36:39], 0
    v_cvt_pk_bf16_f32 v54, v148, v149
    v_cvt_pk_bf16_f32 v55, v150, v151
    ds_write_b128 v252, v[52:55] offset:6144
    v_mfma_f32_16x16x32_bf16 v[100:103], v[224:227], v[36:39], 0
    v_pk_fma_f32 v[56:57], v[56:57], s[50:51], v[240:241] op_sel_hi:[1,1,0] neg_lo:[0,0,1] neg_hi:[0,0,1]
    v_pk_fma_f32 v[58:59], v[58:59], s[50:51], v[240:241] op_sel_hi:[1,1,0] neg_lo:[0,0,1] neg_hi:[0,0,1]
    v_pk_fma_f32 v[152:153], v[152:153], s[50:51], v[240:241] op_sel_hi:[1,1,0] neg_lo:[0,0,1] neg_hi:[0,0,1]
    v_mfma_f32_16x16x32_bf16 v[104:107], v[220:223], v[40:43], 0
    v_pk_fma_f32 v[154:155], v[154:155], s[50:51], v[240:241] op_sel_hi:[1,1,0] neg_lo:[0,0,1] neg_hi:[0,0,1]
    v_mfma_f32_16x16x32_bf16 v[200:203], v[192:195], v[52:55], v[200:203]
    v_exp_f32 v56, v56
    v_mfma_f32_16x16x32_bf16 v[108:111], v[224:227], v[40:43], 0
    v_exp_f32 v57, v57
    v_exp_f32 v58, v58
    v_exp_f32 v59, v59
    v_mfma_f32_16x16x32_bf16 v[112:115], v[220:223], v[44:47], 0
    v_exp_f32 v152, v152
    v_exp_f32 v153, v153
    v_exp_f32 v154, v154
    v_mfma_f32_16x16x32_bf16 v[116:119], v[224:227], v[44:47], 0
    v_exp_f32 v155, v155
    v_cvt_pk_bf16_f32 v56, v56, v57
    v_cvt_pk_bf16_f32 v57, v58, v59
    s_waitcnt lgkmcnt(0)
    v_mfma_f32_16x16x32_bf16 v[0:3], v[228:231], v[120:123], v[0:3]
    ds_read_b64_tr_b16 v[220:221], v242 offset:16384
    ds_read_b64_tr_b16 v[222:223], v242 offset:17408
    v_cvt_pk_bf16_f32 v58, v152, v153
    v_cvt_pk_bf16_f32 v59, v154, v155
    ds_write_b128 v252, v[56:59] offset:10240
    v_mfma_f32_16x16x32_bf16 v[4:7], v[232:235], v[120:123], v[4:7]
    ds_read_b64_tr_b16 v[224:225], v243 offset:16384
    ds_read_b64_tr_b16 v[226:227], v243 offset:17408
    v_pk_fma_f32 v[60:61], v[60:61], s[50:51], v[244:245] op_sel_hi:[1,1,0] neg_lo:[0,0,1] neg_hi:[0,0,1]
    v_pk_fma_f32 v[62:63], v[62:63], s[50:51], v[244:245] op_sel_hi:[1,1,0] neg_lo:[0,0,1] neg_hi:[0,0,1]
    v_pk_fma_f32 v[156:157], v[156:157], s[50:51], v[244:245] op_sel_hi:[1,1,0] neg_lo:[0,0,1] neg_hi:[0,0,1]
    v_mfma_f32_16x16x32_bf16 v[8:11], v[228:231], v[124:127], v[8:11]
    ds_read_b128 v[24:27], v237 offset:0
    ds_read_b128 v[28:31], v237 offset:4096
    v_pk_fma_f32 v[158:159], v[158:159], s[50:51], v[244:245] op_sel_hi:[1,1,0] neg_lo:[0,0,1] neg_hi:[0,0,1]
    v_mfma_f32_16x16x32_bf16 v[204:207], v[192:195], v[56:59], v[204:207]
    v_exp_f32 v60, v60
    v_mfma_f32_16x16x32_bf16 v[12:15], v[232:235], v[124:127], v[12:15]
    ds_read_b128 v[32:35], v237 offset:8192
    ds_read_b128 v[36:39], v237 offset:12288
    v_exp_f32 v61, v61
    v_exp_f32 v62, v62
    v_exp_f32 v63, v63
    v_mfma_f32_16x16x32_bf16 v[16:19], v[228:231], v[128:131], v[16:19]
    ds_read_b128 v[40:43], v237 offset:16384
    ds_read_b128 v[44:47], v237 offset:20480
    v_exp_f32 v156, v156
    v_exp_f32 v157, v157
    v_exp_f32 v158, v158
    v_mfma_f32_16x16x32_bf16 v[20:23], v[232:235], v[128:131], v[20:23]
    v_exp_f32 v159, v159
    v_cvt_pk_bf16_f32 v60, v60, v61
    v_cvt_pk_bf16_f32 v61, v62, v63
    v_mfma_f32_16x16x32_bf16 v[96:99], v[228:231], v[132:135], v[96:99]
    v_cvt_pk_bf16_f32 v62, v156, v157
    v_cvt_pk_bf16_f32 v63, v158, v159
    ds_write_b128 v252, v[60:63] offset:14336
    v_mfma_f32_16x16x32_bf16 v[100:103], v[232:235], v[132:135], v[100:103]
    v_pk_fma_f32 v[64:65], v[64:65], s[50:51], v[246:247] op_sel_hi:[1,1,0] neg_lo:[0,0,1] neg_hi:[0,0,1]
    v_pk_fma_f32 v[66:67], v[66:67], s[50:51], v[246:247] op_sel_hi:[1,1,0] neg_lo:[0,0,1] neg_hi:[0,0,1]
    v_pk_fma_f32 v[160:161], v[160:161], s[50:51], v[246:247] op_sel_hi:[1,1,0] neg_lo:[0,0,1] neg_hi:[0,0,1]
    v_mfma_f32_16x16x32_bf16 v[104:107], v[228:231], v[136:139], v[104:107]
    v_pk_fma_f32 v[162:163], v[162:163], s[50:51], v[246:247] op_sel_hi:[1,1,0] neg_lo:[0,0,1] neg_hi:[0,0,1]
    v_mfma_f32_16x16x32_bf16 v[208:211], v[192:195], v[60:63], v[208:211]
    v_exp_f32 v64, v64
    v_mfma_f32_16x16x32_bf16 v[108:111], v[232:235], v[136:139], v[108:111]
    v_exp_f32 v65, v65
    v_exp_f32 v66, v66
    v_exp_f32 v67, v67
    v_mfma_f32_16x16x32_bf16 v[112:115], v[228:231], v[140:143], v[112:115]
    v_exp_f32 v160, v160
    v_exp_f32 v161, v161
    v_exp_f32 v162, v162
    v_mfma_f32_16x16x32_bf16 v[116:119], v[232:235], v[140:143], v[116:119]
    v_exp_f32 v163, v163
    v_cvt_pk_bf16_f32 v64, v64, v65
    v_cvt_pk_bf16_f32 v65, v66, v67
    s_waitcnt lgkmcnt(0)
    v_mfma_f32_16x16x32_bf16 v[0:3], v[220:223], v[24:27], v[0:3]
    ds_read_b64_tr_b16 v[228:229], v242 offset:24576
    ds_read_b64_tr_b16 v[230:231], v242 offset:25600
    v_cvt_pk_bf16_f32 v66, v160, v161
    v_cvt_pk_bf16_f32 v67, v162, v163
    ds_write_b128 v252, v[64:67] offset:18432
    v_mfma_f32_16x16x32_bf16 v[4:7], v[224:227], v[24:27], v[4:7]
    ds_read_b64_tr_b16 v[232:233], v243 offset:24576
    ds_read_b64_tr_b16 v[234:235], v243 offset:25600
    v_pk_fma_f32 v[68:69], v[68:69], s[50:51], v[248:249] op_sel_hi:[1,1,0] neg_lo:[0,0,1] neg_hi:[0,0,1]
    v_pk_fma_f32 v[70:71], v[70:71], s[50:51], v[248:249] op_sel_hi:[1,1,0] neg_lo:[0,0,1] neg_hi:[0,0,1]
    v_pk_fma_f32 v[164:165], v[164:165], s[50:51], v[248:249] op_sel_hi:[1,1,0] neg_lo:[0,0,1] neg_hi:[0,0,1]
    v_mfma_f32_16x16x32_bf16 v[8:11], v[220:223], v[28:31], v[8:11]
    ds_read_b128 v[120:123], v237 offset:24576
    ds_read_b128 v[124:127], v237 offset:28672
    v_pk_fma_f32 v[166:167], v[166:167], s[50:51], v[248:249] op_sel_hi:[1,1,0] neg_lo:[0,0,1] neg_hi:[0,0,1]
    v_mfma_f32_16x16x32_bf16 v[212:215], v[192:195], v[64:67], v[212:215]
    v_exp_f32 v68, v68
    v_mfma_f32_16x16x32_bf16 v[12:15], v[224:227], v[28:31], v[12:15]
    ds_read_b128 v[128:131], v237 offset:32768
    ds_read_b128 v[132:135], v237 offset:36864
    v_exp_f32 v69, v69
    v_exp_f32 v70, v70
    v_exp_f32 v71, v71
    v_mfma_f32_16x16x32_bf16 v[16:19], v[220:223], v[32:35], v[16:19]
    ds_read_b128 v[136:139], v237 offset:40960
    ds_read_b128 v[140:143], v237 offset:45056
    v_exp_f32 v164, v164
    v_exp_f32 v165, v165
    v_exp_f32 v166, v166
    v_mfma_f32_16x16x32_bf16 v[20:23], v[224:227], v[32:35], v[20:23]
    v_exp_f32 v167, v167
    v_cvt_pk_bf16_f32 v68, v68, v69
    v_cvt_pk_bf16_f32 v69, v70, v71
    v_mfma_f32_16x16x32_bf16 v[96:99], v[220:223], v[36:39], v[96:99]
    v_cvt_pk_bf16_f32 v70, v164, v165
    v_cvt_pk_bf16_f32 v71, v166, v167
    ds_write_b128 v252, v[68:71] offset:22528
    v_mfma_f32_16x16x32_bf16 v[100:103], v[224:227], v[36:39], v[100:103]
    s_nop 1
    v_mfma_f32_16x16x32_bf16 v[216:219], v[192:195], v[68:71], v[216:219]
    v_mfma_f32_16x16x32_bf16 v[104:107], v[220:223], v[40:43], v[104:107]
    v_mfma_f32_16x16x32_bf16 v[108:111], v[224:227], v[40:43], v[108:111]
    v_mfma_f32_16x16x32_bf16 v[112:115], v[220:223], v[44:47], v[112:115]
    v_mfma_f32_16x16x32_bf16 v[116:119], v[224:227], v[44:47], v[116:119]
    s_waitcnt lgkmcnt(0)
    v_mfma_f32_16x16x32_bf16 v[0:3], v[228:231], v[120:123], v[0:3]
    v_mfma_f32_16x16x32_bf16 v[4:7], v[232:235], v[120:123], v[4:7]
    v_mfma_f32_16x16x32_bf16 v[8:11], v[228:231], v[124:127], v[8:11]
    v_mfma_f32_16x16x32_bf16 v[12:15], v[232:235], v[124:127], v[12:15]
    v_mfma_f32_16x16x32_bf16 v[16:19], v[228:231], v[128:131], v[16:19]
    v_mfma_f32_16x16x32_bf16 v[20:23], v[232:235], v[128:131], v[20:23]
    v_mfma_f32_16x16x32_bf16 v[96:99], v[228:231], v[132:135], v[96:99]
    v_mfma_f32_16x16x32_bf16 v[100:103], v[232:235], v[132:135], v[100:103]
    v_mfma_f32_16x16x32_bf16 v[104:107], v[228:231], v[136:139], v[104:107]
    v_mfma_f32_16x16x32_bf16 v[108:111], v[232:235], v[136:139], v[108:111]
    v_mfma_f32_16x16x32_bf16 v[112:115], v[228:231], v[140:143], v[112:115]
    v_mfma_f32_16x16x32_bf16 v[116:119], v[232:235], v[140:143], v[116:119]
    s_waitcnt lgkmcnt(0)
    s_barrier
    ds_read_b64_tr_b16 v[220:221], v242 offset:32768
    ds_read_b64_tr_b16 v[222:223], v242 offset:33792
    ds_read_b64_tr_b16 v[224:225], v243 offset:32768
    ds_read_b64_tr_b16 v[226:227], v243 offset:33792
    ds_read_b128 v[24:27], v255 offset:1024
    ds_read_b128 v[28:31], v255 offset:5120
    ds_read_b128 v[32:35], v255 offset:9216
    ds_read_b128 v[36:39], v255 offset:13312
    ds_read_b128 v[40:43], v255 offset:17408
    ds_read_b128 v[44:47], v255 offset:21504
    v_pk_fma_f32 v[72:73], v[72:73], s[50:51], v[236:237] op_sel_hi:[1,1,0] neg_lo:[0,0,1] neg_hi:[0,0,1]
    v_pk_fma_f32 v[74:75], v[74:75], s[50:51], v[236:237] op_sel_hi:[1,1,0] neg_lo:[0,0,1] neg_hi:[0,0,1]
    v_pk_fma_f32 v[168:169], v[168:169], s[50:51], v[236:237] op_sel_hi:[1,1,0] neg_lo:[0,0,1] neg_hi:[0,0,1]
    v_pk_fma_f32 v[170:171], v[170:171], s[50:51], v[236:237] op_sel_hi:[1,1,0] neg_lo:[0,0,1] neg_hi:[0,0,1]
    v_exp_f32 v72, v72
    v_exp_f32 v73, v73
    v_exp_f32 v74, v74
    v_exp_f32 v75, v75
    v_exp_f32 v168, v168
    v_exp_f32 v169, v169
    v_exp_f32 v170, v170
    v_exp_f32 v171, v171
    v_cvt_pk_bf16_f32 v72, v72, v73
    v_cvt_pk_bf16_f32 v73, v74, v75
    s_waitcnt lgkmcnt(0)
    v_mfma_f32_16x16x32_bf16 v[0:3], v[220:223], v[24:27], v[0:3]
    ds_read_b64_tr_b16 v[228:229], v242 offset:40960
    ds_read_b64_tr_b16 v[230:231], v242 offset:41984
    v_cvt_pk_bf16_f32 v74, v168, v169
    v_cvt_pk_bf16_f32 v75, v170, v171
    ds_write_b128 v252, v[72:75] offset:3072
    v_mfma_f32_16x16x32_bf16 v[4:7], v[224:227], v[24:27], v[4:7]
    ds_read_b64_tr_b16 v[232:233], v243 offset:40960
    ds_read_b64_tr_b16 v[234:235], v243 offset:41984
    v_pk_fma_f32 v[76:77], v[76:77], s[50:51], v[238:239] op_sel_hi:[1,1,0] neg_lo:[0,0,1] neg_hi:[0,0,1]
    v_pk_fma_f32 v[78:79], v[78:79], s[50:51], v[238:239] op_sel_hi:[1,1,0] neg_lo:[0,0,1] neg_hi:[0,0,1]
    v_pk_fma_f32 v[172:173], v[172:173], s[50:51], v[238:239] op_sel_hi:[1,1,0] neg_lo:[0,0,1] neg_hi:[0,0,1]
    v_mfma_f32_16x16x32_bf16 v[8:11], v[220:223], v[28:31], v[8:11]
    ds_read_b128 v[120:123], v255 offset:25600
    ds_read_b128 v[124:127], v255 offset:29696
    v_pk_fma_f32 v[174:175], v[174:175], s[50:51], v[238:239] op_sel_hi:[1,1,0] neg_lo:[0,0,1] neg_hi:[0,0,1]
    v_mfma_f32_16x16x32_bf16 v[196:199], v[192:195], v[72:75], v[196:199]
    v_exp_f32 v76, v76
    v_mfma_f32_16x16x32_bf16 v[12:15], v[224:227], v[28:31], v[12:15]
    ds_read_b128 v[128:131], v255 offset:33792
    ds_read_b128 v[132:135], v255 offset:37888
    v_exp_f32 v77, v77
    v_exp_f32 v78, v78
    v_exp_f32 v79, v79
    v_mfma_f32_16x16x32_bf16 v[16:19], v[220:223], v[32:35], v[16:19]
    ds_read_b128 v[136:139], v255 offset:41984
    ds_read_b128 v[140:143], v255 offset:46080
    v_exp_f32 v172, v172
    v_exp_f32 v173, v173
    v_exp_f32 v174, v174
    v_mfma_f32_16x16x32_bf16 v[20:23], v[224:227], v[32:35], v[20:23]
    v_exp_f32 v175, v175
    v_cvt_pk_bf16_f32 v76, v76, v77
    v_cvt_pk_bf16_f32 v77, v78, v79
    v_mfma_f32_16x16x32_bf16 v[96:99], v[220:223], v[36:39], v[96:99]
    v_cvt_pk_bf16_f32 v78, v172, v173
    v_cvt_pk_bf16_f32 v79, v174, v175
    ds_write_b128 v252, v[76:79] offset:7168
    v_mfma_f32_16x16x32_bf16 v[100:103], v[224:227], v[36:39], v[100:103]
    v_pk_fma_f32 v[80:81], v[80:81], s[50:51], v[240:241] op_sel_hi:[1,1,0] neg_lo:[0,0,1] neg_hi:[0,0,1]
    v_pk_fma_f32 v[82:83], v[82:83], s[50:51], v[240:241] op_sel_hi:[1,1,0] neg_lo:[0,0,1] neg_hi:[0,0,1]
    v_pk_fma_f32 v[176:177], v[176:177], s[50:51], v[240:241] op_sel_hi:[1,1,0] neg_lo:[0,0,1] neg_hi:[0,0,1]
    v_mfma_f32_16x16x32_bf16 v[104:107], v[220:223], v[40:43], v[104:107]
    v_pk_fma_f32 v[178:179], v[178:179], s[50:51], v[240:241] op_sel_hi:[1,1,0] neg_lo:[0,0,1] neg_hi:[0,0,1]
    v_mfma_f32_16x16x32_bf16 v[200:203], v[192:195], v[76:79], v[200:203]
    v_exp_f32 v80, v80
    v_mfma_f32_16x16x32_bf16 v[108:111], v[224:227], v[40:43], v[108:111]
    v_exp_f32 v81, v81
    v_exp_f32 v82, v82
    v_exp_f32 v83, v83
    v_mfma_f32_16x16x32_bf16 v[112:115], v[220:223], v[44:47], v[112:115]
    v_exp_f32 v176, v176
    v_exp_f32 v177, v177
    v_exp_f32 v178, v178
    v_mfma_f32_16x16x32_bf16 v[116:119], v[224:227], v[44:47], v[116:119]
    v_exp_f32 v179, v179
    v_cvt_pk_bf16_f32 v80, v80, v81
    v_cvt_pk_bf16_f32 v81, v82, v83
    s_waitcnt lgkmcnt(0)
    v_mfma_f32_16x16x32_bf16 v[0:3], v[228:231], v[120:123], v[0:3]
    ds_read_b64_tr_b16 v[220:221], v242 offset:49152
    ds_read_b64_tr_b16 v[222:223], v242 offset:50176
    v_cvt_pk_bf16_f32 v82, v176, v177
    v_cvt_pk_bf16_f32 v83, v178, v179
    ds_write_b128 v252, v[80:83] offset:11264
    v_mfma_f32_16x16x32_bf16 v[4:7], v[232:235], v[120:123], v[4:7]
    ds_read_b64_tr_b16 v[224:225], v243 offset:49152
    ds_read_b64_tr_b16 v[226:227], v243 offset:50176
    v_pk_fma_f32 v[84:85], v[84:85], s[50:51], v[244:245] op_sel_hi:[1,1,0] neg_lo:[0,0,1] neg_hi:[0,0,1]
    v_pk_fma_f32 v[86:87], v[86:87], s[50:51], v[244:245] op_sel_hi:[1,1,0] neg_lo:[0,0,1] neg_hi:[0,0,1]
    v_pk_fma_f32 v[180:181], v[180:181], s[50:51], v[244:245] op_sel_hi:[1,1,0] neg_lo:[0,0,1] neg_hi:[0,0,1]
    v_mfma_f32_16x16x32_bf16 v[8:11], v[228:231], v[124:127], v[8:11]
    ds_read_b128 v[24:27], v237 offset:1024
    ds_read_b128 v[28:31], v237 offset:5120
    v_pk_fma_f32 v[182:183], v[182:183], s[50:51], v[244:245] op_sel_hi:[1,1,0] neg_lo:[0,0,1] neg_hi:[0,0,1]
    v_mfma_f32_16x16x32_bf16 v[204:207], v[192:195], v[80:83], v[204:207]
    v_exp_f32 v84, v84
    v_mfma_f32_16x16x32_bf16 v[12:15], v[232:235], v[124:127], v[12:15]
    ds_read_b128 v[32:35], v237 offset:9216
    ds_read_b128 v[36:39], v237 offset:13312
    v_exp_f32 v85, v85
    v_exp_f32 v86, v86
    v_exp_f32 v87, v87
    v_mfma_f32_16x16x32_bf16 v[16:19], v[228:231], v[128:131], v[16:19]
    ds_read_b128 v[40:43], v237 offset:17408
    ds_read_b128 v[44:47], v237 offset:21504
    v_exp_f32 v180, v180
    v_exp_f32 v181, v181
    v_exp_f32 v182, v182
    v_mfma_f32_16x16x32_bf16 v[20:23], v[232:235], v[128:131], v[20:23]
    v_exp_f32 v183, v183
    v_cvt_pk_bf16_f32 v84, v84, v85
    v_cvt_pk_bf16_f32 v85, v86, v87
    v_mfma_f32_16x16x32_bf16 v[96:99], v[228:231], v[132:135], v[96:99]
    v_cvt_pk_bf16_f32 v86, v180, v181
    v_cvt_pk_bf16_f32 v87, v182, v183
    ds_write_b128 v252, v[84:87] offset:15360
    v_mfma_f32_16x16x32_bf16 v[100:103], v[232:235], v[132:135], v[100:103]
    v_pk_fma_f32 v[88:89], v[88:89], s[50:51], v[246:247] op_sel_hi:[1,1,0] neg_lo:[0,0,1] neg_hi:[0,0,1]
    v_pk_fma_f32 v[90:91], v[90:91], s[50:51], v[246:247] op_sel_hi:[1,1,0] neg_lo:[0,0,1] neg_hi:[0,0,1]
    v_pk_fma_f32 v[184:185], v[184:185], s[50:51], v[246:247] op_sel_hi:[1,1,0] neg_lo:[0,0,1] neg_hi:[0,0,1]
    v_mfma_f32_16x16x32_bf16 v[104:107], v[228:231], v[136:139], v[104:107]
    v_pk_fma_f32 v[186:187], v[186:187], s[50:51], v[246:247] op_sel_hi:[1,1,0] neg_lo:[0,0,1] neg_hi:[0,0,1]
    v_mfma_f32_16x16x32_bf16 v[208:211], v[192:195], v[84:87], v[208:211]
    v_exp_f32 v88, v88
    v_mfma_f32_16x16x32_bf16 v[108:111], v[232:235], v[136:139], v[108:111]
    v_exp_f32 v89, v89
    v_exp_f32 v90, v90
    v_exp_f32 v91, v91
    v_mfma_f32_16x16x32_bf16 v[112:115], v[228:231], v[140:143], v[112:115]
    v_exp_f32 v184, v184
    v_exp_f32 v185, v185
    v_exp_f32 v186, v186
    v_mfma_f32_16x16x32_bf16 v[116:119], v[232:235], v[140:143], v[116:119]
    v_exp_f32 v187, v187
    v_cvt_pk_bf16_f32 v88, v88, v89
    v_cvt_pk_bf16_f32 v89, v90, v91
    s_waitcnt lgkmcnt(0)
    v_mfma_f32_16x16x32_bf16 v[0:3], v[220:223], v[24:27], v[0:3]
    ds_read_b64_tr_b16 v[228:229], v242 offset:57344
    ds_read_b64_tr_b16 v[230:231], v242 offset:58368
    v_cvt_pk_bf16_f32 v90, v184, v185
    v_cvt_pk_bf16_f32 v91, v186, v187
    ds_write_b128 v252, v[88:91] offset:19456
    v_mfma_f32_16x16x32_bf16 v[4:7], v[224:227], v[24:27], v[4:7]
    ds_read_b64_tr_b16 v[232:233], v243 offset:57344
    ds_read_b64_tr_b16 v[234:235], v243 offset:58368
    v_pk_fma_f32 v[92:93], v[92:93], s[50:51], v[248:249] op_sel_hi:[1,1,0] neg_lo:[0,0,1] neg_hi:[0,0,1]
    v_pk_fma_f32 v[94:95], v[94:95], s[50:51], v[248:249] op_sel_hi:[1,1,0] neg_lo:[0,0,1] neg_hi:[0,0,1]
    v_pk_fma_f32 v[188:189], v[188:189], s[50:51], v[248:249] op_sel_hi:[1,1,0] neg_lo:[0,0,1] neg_hi:[0,0,1]
    v_mfma_f32_16x16x32_bf16 v[8:11], v[220:223], v[28:31], v[8:11]
    ds_read_b128 v[120:123], v237 offset:25600
    ds_read_b128 v[124:127], v237 offset:29696
    v_pk_fma_f32 v[190:191], v[190:191], s[50:51], v[248:249] op_sel_hi:[1,1,0] neg_lo:[0,0,1] neg_hi:[0,0,1]
    v_mfma_f32_16x16x32_bf16 v[212:215], v[192:195], v[88:91], v[212:215]
    v_exp_f32 v92, v92
    v_mfma_f32_16x16x32_bf16 v[12:15], v[224:227], v[28:31], v[12:15]
    ds_read_b128 v[128:131], v237 offset:33792
    ds_read_b128 v[132:135], v237 offset:37888
    v_exp_f32 v93, v93
    v_exp_f32 v94, v94
    v_exp_f32 v95, v95
    v_mfma_f32_16x16x32_bf16 v[16:19], v[220:223], v[32:35], v[16:19]
    ds_read_b128 v[136:139], v237 offset:41984
    ds_read_b128 v[140:143], v237 offset:46080
    v_exp_f32 v188, v188
    v_exp_f32 v189, v189
    v_exp_f32 v190, v190
    v_mfma_f32_16x16x32_bf16 v[20:23], v[224:227], v[32:35], v[20:23]
    v_exp_f32 v191, v191
    v_cvt_pk_bf16_f32 v92, v92, v93
    v_cvt_pk_bf16_f32 v93, v94, v95
    v_mfma_f32_16x16x32_bf16 v[96:99], v[220:223], v[36:39], v[96:99]
    v_cvt_pk_bf16_f32 v94, v188, v189
    v_cvt_pk_bf16_f32 v95, v190, v191
    ds_write_b128 v252, v[92:95] offset:23552
    v_mfma_f32_16x16x32_bf16 v[100:103], v[224:227], v[36:39], v[100:103]
    s_nop 1
    v_mfma_f32_16x16x32_bf16 v[216:219], v[192:195], v[92:95], v[216:219]
    v_mfma_f32_16x16x32_bf16 v[104:107], v[220:223], v[40:43], v[104:107]
    v_mfma_f32_16x16x32_bf16 v[108:111], v[224:227], v[40:43], v[108:111]
    v_mfma_f32_16x16x32_bf16 v[112:115], v[220:223], v[44:47], v[112:115]
    v_mfma_f32_16x16x32_bf16 v[116:119], v[224:227], v[44:47], v[116:119]
    s_waitcnt lgkmcnt(0)
    v_mfma_f32_16x16x32_bf16 v[0:3], v[228:231], v[120:123], v[0:3]
    v_mfma_f32_16x16x32_bf16 v[4:7], v[232:235], v[120:123], v[4:7]
    v_mfma_f32_16x16x32_bf16 v[8:11], v[228:231], v[124:127], v[8:11]
    v_mfma_f32_16x16x32_bf16 v[12:15], v[232:235], v[124:127], v[12:15]
    v_mfma_f32_16x16x32_bf16 v[16:19], v[228:231], v[128:131], v[16:19]
    v_mfma_f32_16x16x32_bf16 v[20:23], v[232:235], v[128:131], v[20:23]
    v_mfma_f32_16x16x32_bf16 v[96:99], v[228:231], v[132:135], v[96:99]
    v_mfma_f32_16x16x32_bf16 v[100:103], v[232:235], v[132:135], v[100:103]
    v_mfma_f32_16x16x32_bf16 v[104:107], v[228:231], v[136:139], v[104:107]
    v_mfma_f32_16x16x32_bf16 v[108:111], v[232:235], v[136:139], v[108:111]
    v_mfma_f32_16x16x32_bf16 v[112:115], v[228:231], v[140:143], v[112:115]
    v_mfma_f32_16x16x32_bf16 v[116:119], v[232:235], v[140:143], v[116:119]
    s_nop 7
    s_waitcnt lgkmcnt(0)
    s_barrier
    ds_write_b32 v239, v196 offset:0
    ds_write_b32 v239, v200 offset:4
    ds_write_b32 v239, v204 offset:8
    ds_write_b32 v239, v208 offset:12
    ds_write_b32 v239, v212 offset:16
    ds_write_b32 v239, v216 offset:20
    ds_read_b64_tr_b16 v[220:221], v242 offset:0
    ds_read_b64_tr_b16 v[222:223], v242 offset:1024
    ds_read_b64_tr_b16 v[224:225], v243 offset:0
    ds_read_b64_tr_b16 v[226:227], v243 offset:1024
    ds_read_b128 v[24:27], v255 offset:2048
    ds_read_b128 v[28:31], v255 offset:6144
    ds_read_b128 v[32:35], v255 offset:10240
    ds_read_b128 v[36:39], v255 offset:14336
    ds_read_b128 v[40:43], v255 offset:18432
    ds_read_b128 v[44:47], v255 offset:22528
    s_waitcnt lgkmcnt(0)
    v_mfma_f32_16x16x32_bf16 v[0:3], v[220:223], v[24:27], v[0:3]
    ds_read_b64_tr_b16 v[228:229], v242 offset:8192
    ds_read_b64_tr_b16 v[230:231], v242 offset:9216
    v_mfma_f32_16x16x32_bf16 v[4:7], v[224:227], v[24:27], v[4:7]
    ds_read_b64_tr_b16 v[232:233], v243 offset:8192
    ds_read_b64_tr_b16 v[234:235], v243 offset:9216
    v_mfma_f32_16x16x32_bf16 v[8:11], v[220:223], v[28:31], v[8:11]
    ds_read_b128 v[120:123], v255 offset:26624
    ds_read_b128 v[124:127], v255 offset:30720
    v_mfma_f32_16x16x32_bf16 v[12:15], v[224:227], v[28:31], v[12:15]
    ds_read_b128 v[128:131], v255 offset:34816
    ds_read_b128 v[132:135], v255 offset:38912
    v_mfma_f32_16x16x32_bf16 v[16:19], v[220:223], v[32:35], v[16:19]
    ds_read_b128 v[136:139], v255 offset:43008
    ds_read_b128 v[140:143], v255 offset:47104
    v_mfma_f32_16x16x32_bf16 v[20:23], v[224:227], v[32:35], v[20:23]
    v_mfma_f32_16x16x32_bf16 v[96:99], v[220:223], v[36:39], v[96:99]
    v_mfma_f32_16x16x32_bf16 v[100:103], v[224:227], v[36:39], v[100:103]
    v_mfma_f32_16x16x32_bf16 v[104:107], v[220:223], v[40:43], v[104:107]
    v_mfma_f32_16x16x32_bf16 v[108:111], v[224:227], v[40:43], v[108:111]
    v_mfma_f32_16x16x32_bf16 v[112:115], v[220:223], v[44:47], v[112:115]
    v_mfma_f32_16x16x32_bf16 v[116:119], v[224:227], v[44:47], v[116:119]
    s_waitcnt lgkmcnt(0)
    v_mfma_f32_16x16x32_bf16 v[0:3], v[228:231], v[120:123], v[0:3]
    ds_read_b64_tr_b16 v[220:221], v242 offset:16384
    ds_read_b64_tr_b16 v[222:223], v242 offset:17408
    v_mfma_f32_16x16x32_bf16 v[4:7], v[232:235], v[120:123], v[4:7]
    ds_read_b64_tr_b16 v[224:225], v243 offset:16384
    ds_read_b64_tr_b16 v[226:227], v243 offset:17408
    v_mfma_f32_16x16x32_bf16 v[8:11], v[228:231], v[124:127], v[8:11]
    ds_read_b128 v[24:27], v237 offset:2048
    ds_read_b128 v[28:31], v237 offset:6144
    v_mfma_f32_16x16x32_bf16 v[12:15], v[232:235], v[124:127], v[12:15]
    ds_read_b128 v[32:35], v237 offset:10240
    ds_read_b128 v[36:39], v237 offset:14336
    v_mfma_f32_16x16x32_bf16 v[16:19], v[228:231], v[128:131], v[16:19]
    ds_read_b128 v[40:43], v237 offset:18432
    ds_read_b128 v[44:47], v237 offset:22528
    v_mfma_f32_16x16x32_bf16 v[20:23], v[232:235], v[128:131], v[20:23]
    v_mfma_f32_16x16x32_bf16 v[96:99], v[228:231], v[132:135], v[96:99]
    v_mfma_f32_16x16x32_bf16 v[100:103], v[232:235], v[132:135], v[100:103]
    v_mfma_f32_16x16x32_bf16 v[104:107], v[228:231], v[136:139], v[104:107]
    v_mfma_f32_16x16x32_bf16 v[108:111], v[232:235], v[136:139], v[108:111]
    v_mfma_f32_16x16x32_bf16 v[112:115], v[228:231], v[140:143], v[112:115]
    v_mfma_f32_16x16x32_bf16 v[116:119], v[232:235], v[140:143], v[116:119]
    s_waitcnt lgkmcnt(0)
    v_mfma_f32_16x16x32_bf16 v[0:3], v[220:223], v[24:27], v[0:3]
    ds_read_b64_tr_b16 v[228:229], v242 offset:24576
    ds_read_b64_tr_b16 v[230:231], v242 offset:25600
    v_mfma_f32_16x16x32_bf16 v[4:7], v[224:227], v[24:27], v[4:7]
    ds_read_b64_tr_b16 v[232:233], v243 offset:24576
    ds_read_b64_tr_b16 v[234:235], v243 offset:25600
    v_mfma_f32_16x16x32_bf16 v[8:11], v[220:223], v[28:31], v[8:11]
    ds_read_b128 v[120:123], v237 offset:26624
    ds_read_b128 v[124:127], v237 offset:30720
    v_mfma_f32_16x16x32_bf16 v[12:15], v[224:227], v[28:31], v[12:15]
    ds_read_b128 v[128:131], v237 offset:34816
    ds_read_b128 v[132:135], v237 offset:38912
    v_mfma_f32_16x16x32_bf16 v[16:19], v[220:223], v[32:35], v[16:19]
    ds_read_b128 v[136:139], v237 offset:43008
    ds_read_b128 v[140:143], v237 offset:47104
    v_mfma_f32_16x16x32_bf16 v[20:23], v[224:227], v[32:35], v[20:23]
    v_mfma_f32_16x16x32_bf16 v[96:99], v[220:223], v[36:39], v[96:99]
    v_mfma_f32_16x16x32_bf16 v[100:103], v[224:227], v[36:39], v[100:103]
    v_mfma_f32_16x16x32_bf16 v[104:107], v[220:223], v[40:43], v[104:107]
    v_mfma_f32_16x16x32_bf16 v[108:111], v[224:227], v[40:43], v[108:111]
    v_mfma_f32_16x16x32_bf16 v[112:115], v[220:223], v[44:47], v[112:115]
    v_mfma_f32_16x16x32_bf16 v[116:119], v[224:227], v[44:47], v[116:119]
    s_waitcnt lgkmcnt(0)
    v_mfma_f32_16x16x32_bf16 v[0:3], v[228:231], v[120:123], v[0:3]
    v_mfma_f32_16x16x32_bf16 v[4:7], v[232:235], v[120:123], v[4:7]
    v_mfma_f32_16x16x32_bf16 v[8:11], v[228:231], v[124:127], v[8:11]
    v_mfma_f32_16x16x32_bf16 v[12:15], v[232:235], v[124:127], v[12:15]
    v_mfma_f32_16x16x32_bf16 v[16:19], v[228:231], v[128:131], v[16:19]
    v_mfma_f32_16x16x32_bf16 v[20:23], v[232:235], v[128:131], v[20:23]
    v_mfma_f32_16x16x32_bf16 v[96:99], v[228:231], v[132:135], v[96:99]
    v_mfma_f32_16x16x32_bf16 v[100:103], v[232:235], v[132:135], v[100:103]
    v_mfma_f32_16x16x32_bf16 v[104:107], v[228:231], v[136:139], v[104:107]
    v_mfma_f32_16x16x32_bf16 v[108:111], v[232:235], v[136:139], v[108:111]
    v_mfma_f32_16x16x32_bf16 v[112:115], v[228:231], v[140:143], v[112:115]
    v_mfma_f32_16x16x32_bf16 v[116:119], v[232:235], v[140:143], v[116:119]
    s_waitcnt lgkmcnt(0)
    s_barrier
    ds_read_b64_tr_b16 v[220:221], v242 offset:32768
    ds_read_b64_tr_b16 v[222:223], v242 offset:33792
    ds_read_b64_tr_b16 v[224:225], v243 offset:32768
    ds_read_b64_tr_b16 v[226:227], v243 offset:33792
    ds_read_b128 v[24:27], v255 offset:3072
    ds_read_b128 v[28:31], v255 offset:7168
    ds_read_b128 v[32:35], v255 offset:11264
    ds_read_b128 v[36:39], v255 offset:15360
    ds_read_b128 v[40:43], v255 offset:19456
    ds_read_b128 v[44:47], v255 offset:23552
    ds_read_b128 v[48:51], v245 offset:0
    ds_read_b64 v[52:53], v245 offset:16
    ds_read_b128 v[56:59], v245 offset:24576
    ds_read_b64 v[60:61], v245 offset:24592
    ds_read_b128 v[64:67], v247 offset:0
    ds_read_b64 v[68:69], v247 offset:16
    ds_read_b128 v[72:75], v247 offset:24576
    ds_read_b64 v[76:77], v247 offset:24592
    s_waitcnt lgkmcnt(0)
    v_mfma_f32_16x16x32_bf16 v[0:3], v[220:223], v[24:27], v[0:3]
    ds_read_b64_tr_b16 v[228:229], v242 offset:40960
    ds_read_b64_tr_b16 v[230:231], v242 offset:41984
    v_mfma_f32_16x16x32_bf16 v[4:7], v[224:227], v[24:27], v[4:7]
    ds_read_b64_tr_b16 v[232:233], v243 offset:40960
    ds_read_b64_tr_b16 v[234:235], v243 offset:41984
    v_mfma_f32_16x16x32_bf16 v[8:11], v[220:223], v[28:31], v[8:11]
    ds_read_b128 v[120:123], v255 offset:27648
    ds_read_b128 v[124:127], v255 offset:31744
    v_mfma_f32_16x16x32_bf16 v[12:15], v[224:227], v[28:31], v[12:15]
    ds_read_b128 v[128:131], v255 offset:35840
    ds_read_b128 v[132:135], v255 offset:39936
    v_mfma_f32_16x16x32_bf16 v[16:19], v[220:223], v[32:35], v[16:19]
    ds_read_b128 v[136:139], v255 offset:44032
    ds_read_b128 v[140:143], v255 offset:48128
    v_mfma_f32_16x16x32_bf16 v[20:23], v[224:227], v[32:35], v[20:23]
    v_mfma_f32_16x16x32_bf16 v[96:99], v[220:223], v[36:39], v[96:99]
    v_mfma_f32_16x16x32_bf16 v[100:103], v[224:227], v[36:39], v[100:103]
    v_mfma_f32_16x16x32_bf16 v[104:107], v[220:223], v[40:43], v[104:107]
    v_mfma_f32_16x16x32_bf16 v[108:111], v[224:227], v[40:43], v[108:111]
    v_mfma_f32_16x16x32_bf16 v[112:115], v[220:223], v[44:47], v[112:115]
    v_mfma_f32_16x16x32_bf16 v[116:119], v[224:227], v[44:47], v[116:119]
    s_waitcnt lgkmcnt(0)
    v_mfma_f32_16x16x32_bf16 v[0:3], v[228:231], v[120:123], v[0:3]
    ds_read_b64_tr_b16 v[220:221], v242 offset:49152
    ds_read_b64_tr_b16 v[222:223], v242 offset:50176
    v_mfma_f32_16x16x32_bf16 v[4:7], v[232:235], v[120:123], v[4:7]
    ds_read_b64_tr_b16 v[224:225], v243 offset:49152
    ds_read_b64_tr_b16 v[226:227], v243 offset:50176
    v_mfma_f32_16x16x32_bf16 v[8:11], v[228:231], v[124:127], v[8:11]
    ds_read_b128 v[24:27], v237 offset:3072
    ds_read_b128 v[28:31], v237 offset:7168
    v_mfma_f32_16x16x32_bf16 v[12:15], v[232:235], v[124:127], v[12:15]
    ds_read_b128 v[32:35], v237 offset:11264
    ds_read_b128 v[36:39], v237 offset:15360
    v_mfma_f32_16x16x32_bf16 v[16:19], v[228:231], v[128:131], v[16:19]
    ds_read_b128 v[40:43], v237 offset:19456
    ds_read_b128 v[44:47], v237 offset:23552
    v_mfma_f32_16x16x32_bf16 v[20:23], v[232:235], v[128:131], v[20:23]
    v_mfma_f32_16x16x32_bf16 v[96:99], v[228:231], v[132:135], v[96:99]
    v_mfma_f32_16x16x32_bf16 v[100:103], v[232:235], v[132:135], v[100:103]
    v_mfma_f32_16x16x32_bf16 v[104:107], v[228:231], v[136:139], v[104:107]
    v_mfma_f32_16x16x32_bf16 v[108:111], v[232:235], v[136:139], v[108:111]
    v_mfma_f32_16x16x32_bf16 v[112:115], v[228:231], v[140:143], v[112:115]
    v_mfma_f32_16x16x32_bf16 v[116:119], v[232:235], v[140:143], v[116:119]
    v_pk_add_f32 v[48:49], v[48:49], v[56:57]
    v_pk_add_f32 v[64:65], v[64:65], v[72:73]
    v_pk_add_f32 v[48:49], v[48:49], v[64:65]
    v_pk_add_f32 v[50:51], v[50:51], v[58:59]
    v_pk_add_f32 v[66:67], v[66:67], v[74:75]
    v_pk_add_f32 v[50:51], v[50:51], v[66:67]
    v_pk_add_f32 v[52:53], v[52:53], v[60:61]
    v_pk_add_f32 v[68:69], v[68:69], v[76:77]
    v_pk_add_f32 v[52:53], v[52:53], v[68:69]
    v_rcp_f32 v80, v48
    v_rcp_f32 v82, v49
    v_rcp_f32 v84, v50
    v_rcp_f32 v86, v51
    v_rcp_f32 v88, v52
    v_rcp_f32 v90, v53
    s_waitcnt lgkmcnt(0)
    v_mfma_f32_16x16x32_bf16 v[0:3], v[220:223], v[24:27], v[0:3]
    ds_read_b64_tr_b16 v[228:229], v242 offset:57344
    ds_read_b64_tr_b16 v[230:231], v242 offset:58368
    v_mfma_f32_16x16x32_bf16 v[4:7], v[224:227], v[24:27], v[4:7]
    ds_read_b64_tr_b16 v[232:233], v243 offset:57344
    ds_read_b64_tr_b16 v[234:235], v243 offset:58368
    v_mfma_f32_16x16x32_bf16 v[8:11], v[220:223], v[28:31], v[8:11]
    ds_read_b128 v[120:123], v237 offset:27648
    ds_read_b128 v[124:127], v237 offset:31744
    v_mfma_f32_16x16x32_bf16 v[12:15], v[224:227], v[28:31], v[12:15]
    ds_read_b128 v[128:131], v237 offset:35840
    ds_read_b128 v[132:135], v237 offset:39936
    v_mfma_f32_16x16x32_bf16 v[16:19], v[220:223], v[32:35], v[16:19]
    ds_read_b128 v[136:139], v237 offset:44032
    ds_read_b128 v[140:143], v237 offset:48128
    v_mfma_f32_16x16x32_bf16 v[20:23], v[224:227], v[32:35], v[20:23]
    v_mfma_f32_16x16x32_bf16 v[96:99], v[220:223], v[36:39], v[96:99]
    v_mfma_f32_16x16x32_bf16 v[100:103], v[224:227], v[36:39], v[100:103]
    v_mfma_f32_16x16x32_bf16 v[104:107], v[220:223], v[40:43], v[104:107]
    v_mfma_f32_16x16x32_bf16 v[108:111], v[224:227], v[40:43], v[108:111]
    v_mfma_f32_16x16x32_bf16 v[112:115], v[220:223], v[44:47], v[112:115]
    v_mfma_f32_16x16x32_bf16 v[116:119], v[224:227], v[44:47], v[116:119]
    s_waitcnt lgkmcnt(0)
    v_mfma_f32_16x16x32_bf16 v[0:3], v[228:231], v[120:123], v[0:3]
    v_mfma_f32_16x16x32_bf16 v[4:7], v[232:235], v[120:123], v[4:7]
    v_mfma_f32_16x16x32_bf16 v[8:11], v[228:231], v[124:127], v[8:11]
    v_mfma_f32_16x16x32_bf16 v[12:15], v[232:235], v[124:127], v[12:15]
    v_mfma_f32_16x16x32_bf16 v[16:19], v[228:231], v[128:131], v[16:19]
    v_mfma_f32_16x16x32_bf16 v[20:23], v[232:235], v[128:131], v[20:23]
    v_mfma_f32_16x16x32_bf16 v[96:99], v[228:231], v[132:135], v[96:99]
    v_mfma_f32_16x16x32_bf16 v[100:103], v[232:235], v[132:135], v[100:103]
    v_mfma_f32_16x16x32_bf16 v[104:107], v[228:231], v[136:139], v[104:107]
    v_mfma_f32_16x16x32_bf16 v[108:111], v[232:235], v[136:139], v[108:111]
    v_mfma_f32_16x16x32_bf16 v[112:115], v[228:231], v[140:143], v[112:115]
    v_mfma_f32_16x16x32_bf16 v[116:119], v[232:235], v[140:143], v[116:119]
    s_lshl_b32 s50, s44, 6
    s_add_u32 s50, s50, s45
    s_lshl_b32 s50, s50, 2
    s_add_u32 s50, s50, s46
    s_mul_i32 s50, s50, 3072
    s_add_u32 s51, s50, 393216
    s_nop 3
    v_pk_mul_f32 v[0:1], v[0:1], v[80:81] op_sel_hi:[1,0]
    v_pk_mul_f32 v[2:3], v[2:3], v[80:81] op_sel_hi:[1,0]
    v_pk_mul_f32 v[4:5], v[4:5], v[80:81] op_sel_hi:[1,0]
    v_pk_mul_f32 v[6:7], v[6:7], v[80:81] op_sel_hi:[1,0]
    v_cvt_pk_bf16_f32 v144, v0, v1
    v_cvt_pk_bf16_f32 v145, v2, v3
    v_cvt_pk_bf16_f32 v146, v4, v5
    v_cvt_pk_bf16_f32 v147, v6, v7
    buffer_store_dwordx4 v[144:147], v255, s[40:43], s50 offen offset:0 sc1
    v_pk_mul_f32 v[8:9], v[8:9], v[82:83] op_sel_hi:[1,0]
    v_pk_mul_f32 v[10:11], v[10:11], v[82:83] op_sel_hi:[1,0]
    v_pk_mul_f32 v[12:13], v[12:13], v[82:83] op_sel_hi:[1,0]
    v_pk_mul_f32 v[14:15], v[14:15], v[82:83] op_sel_hi:[1,0]
    v_cvt_pk_bf16_f32 v148, v8, v9
    v_cvt_pk_bf16_f32 v149, v10, v11
    v_cvt_pk_bf16_f32 v150, v12, v13
    v_cvt_pk_bf16_f32 v151, v14, v15
    buffer_store_dwordx4 v[148:151], v255, s[40:43], s50 offen offset:1024 sc1
    v_pk_mul_f32 v[16:17], v[16:17], v[84:85] op_sel_hi:[1,0]
    v_pk_mul_f32 v[18:19], v[18:19], v[84:85] op_sel_hi:[1,0]
    v_pk_mul_f32 v[20:21], v[20:21], v[84:85] op_sel_hi:[1,0]
    v_pk_mul_f32 v[22:23], v[22:23], v[84:85] op_sel_hi:[1,0]
    v_cvt_pk_bf16_f32 v152, v16, v17
    v_cvt_pk_bf16_f32 v153, v18, v19
    v_cvt_pk_bf16_f32 v154, v20, v21
    v_cvt_pk_bf16_f32 v155, v22, v23
    buffer_store_dwordx4 v[152:155], v255, s[40:43], s50 offen offset:2048 sc1
    v_pk_mul_f32 v[96:97], v[96:97], v[86:87] op_sel_hi:[1,0]
    v_pk_mul_f32 v[98:99], v[98:99], v[86:87] op_sel_hi:[1,0]
    v_pk_mul_f32 v[100:101], v[100:101], v[86:87] op_sel_hi:[1,0]
    v_pk_mul_f32 v[102:103], v[102:103], v[86:87] op_sel_hi:[1,0]
    v_cvt_pk_bf16_f32 v156, v96, v97
    v_cvt_pk_bf16_f32 v157, v98, v99
    v_cvt_pk_bf16_f32 v158, v100, v101
    v_cvt_pk_bf16_f32 v159, v102, v103
    buffer_store_dwordx4 v[156:159], v255, s[40:43], s51 offen offset:0 sc1
    v_pk_mul_f32 v[104:105], v[104:105], v[88:89] op_sel_hi:[1,0]
    v_pk_mul_f32 v[106:107], v[106:107], v[88:89] op_sel_hi:[1,0]
    v_pk_mul_f32 v[108:109], v[108:109], v[88:89] op_sel_hi:[1,0]
    v_pk_mul_f32 v[110:111], v[110:111], v[88:89] op_sel_hi:[1,0]
    v_cvt_pk_bf16_f32 v160, v104, v105
    v_cvt_pk_bf16_f32 v161, v106, v107
    v_cvt_pk_bf16_f32 v162, v108, v109
    v_cvt_pk_bf16_f32 v163, v110, v111
    buffer_store_dwordx4 v[160:163], v255, s[40:43], s51 offen offset:1024 sc1
    v_pk_mul_f32 v[112:113], v[112:113], v[90:91] op_sel_hi:[1,0]
    v_pk_mul_f32 v[114:115], v[114:115], v[90:91] op_sel_hi:[1,0]
    v_pk_mul_f32 v[116:117], v[116:117], v[90:91] op_sel_hi:[1,0]
    v_pk_mul_f32 v[118:119], v[118:119], v[90:91] op_sel_hi:[1,0]
    v_cvt_pk_bf16_f32 v164, v112, v113
    v_cvt_pk_bf16_f32 v165, v114, v115
    v_cvt_pk_bf16_f32 v166, v116, v117
    v_cvt_pk_bf16_f32 v167, v118, v119
    buffer_store_dwordx4 v[164:167], v255, s[40:43], s51 offen offset:2048 sc1
    s_endpgm
K1_LOADER:
    v_lshl_add_u32 v39, v33, 1, 0
    v_and_b32 v39, 3, v39
    v_lshl_add_u32 v39, v39, 2, v36
    v_xor_b32 v42, v39, v35
    v_lshlrev_b32 v42, 4, v42
    v_lshl_add_u32 v232, v36, 10, v42
    v_lshl_add_u32 v39, v33, 1, 1
    v_and_b32 v39, 3, v39
    v_lshl_add_u32 v39, v39, 2, v36
    v_xor_b32 v42, v39, v35
    v_lshlrev_b32 v42, 4, v42
    v_lshl_add_u32 v233, v36, 10, v42
    v_lshl_add_u32 v39, v33, 1, 2
    v_and_b32 v39, 3, v39
    v_lshl_add_u32 v39, v39, 2, v36
    v_xor_b32 v42, v39, v35
    v_lshlrev_b32 v42, 4, v42
    v_lshl_add_u32 v234, v36, 10, v42
    v_lshl_add_u32 v39, v33, 1, 3
    v_and_b32 v39, 3, v39
    v_lshl_add_u32 v39, v39, 2, v36
    v_xor_b32 v42, v39, v35
    v_lshlrev_b32 v42, 4, v42
    v_lshl_add_u32 v235, v36, 10, v42
    s_mul_i32 s57, s44, 98304
    s_mul_i32 s51, s46, 24576
    s_add_u32 s57, s57, s51
    s_mul_i32 s62, s46, 6144
    s_waitcnt lgkmcnt(0)
    s_mov_b32 s20, s4
    s_and_b32 s21, s5, 0xffff
    s_mov_b32 s22, 786432
    s_mov_b32 s23, 0x00020000
    s_and_b32 s63, s44, 1
    s_mov_b32 s28, s8
    s_and_b32 s29, s9, 0xffff
    s_mov_b32 s30, 33554432
    s_mov_b32 s31, 0x00020000
    v_and_b32 v39, 1, v33
    v_lshl_add_u32 v39, v39, 2, v36
    v_lshlrev_b32 v39, 1, v39
    v_xor_b32 v39, v39, v35
    v_lshlrev_b32 v39, 4, v39
    v_lshl_add_u32 v240, v36, 13, v39
    v_lshl_add_u32 v241, v36, 8, v39
    s_lshl_b32 s61, s44, 5
    s_add_u32 s61, s61, s45
    s_lshl_b32 s61, s61, 17
    s_lshl_b32 s59, s46, 15
    s_add_u32 s60, s61, s59
    s_lshl_b32 s59, s46, 11
    s_add_u32 s61, s61, s59
    s_lshl_b32 s59, s46, 12
    s_mov_b32 s24, s6
    s_and_b32 s25, s7, 0xffff
    s_mov_b32 s26, 33554432
    s_mov_b32 s27, 0x00020000
    v_add_u32 v39, 0, v36
    v_xor_b32 v42, v39, v35
    v_lshlrev_b32 v42, 4, v42
    v_add_u32 v39, 0, v36
    v_lshl_add_u32 v236, v39, 8, v42
    v_add_u32 v39, 4, v36
    v_xor_b32 v42, v39, v35
    v_lshlrev_b32 v42, 4, v42
    v_add_u32 v39, 8, v36
    v_lshl_add_u32 v237, v39, 8, v42
    v_add_u32 v39, 8, v36
    v_xor_b32 v42, v39, v35
    v_lshlrev_b32 v42, 4, v42
    v_add_u32 v39, 16, v36
    v_lshl_add_u32 v238, v39, 8, v42
    v_add_u32 v39, 12, v36
    v_xor_b32 v42, v39, v35
    v_lshlrev_b32 v42, 4, v42
    v_add_u32 v39, 24, v36
    v_lshl_add_u32 v239, v39, 8, v42
    v_add_u32 v227, s59, v255
    v_add_u32 v228, 98304, v227
    v_add_u32 v227, 24576, v227
    s_cmp_lg_u32 s63, 1
    s_cbranch_scc1 K1_G1
    s_add_u32 s50, s60, 0
    buffer_load_dwordx4 v[64:67], v236, s[24:27], s50 offen nt
    buffer_load_dwordx4 v[68:71], v237, s[24:27], s50 offen nt
    buffer_load_dwordx4 v[72:75], v238, s[24:27], s50 offen nt
    buffer_load_dwordx4 v[76:79], v239, s[24:27], s50 offen nt
    s_add_u32 s50, s60, 1024
    buffer_load_dwordx4 v[80:83], v236, s[24:27], s50 offen nt
    buffer_load_dwordx4 v[84:87], v237, s[24:27], s50 offen nt
    buffer_load_dwordx4 v[88:91], v238, s[24:27], s50 offen nt
    buffer_load_dwordx4 v[92:95], v239, s[24:27], s50 offen nt
    s_add_u32 s50, s60, 8192
    buffer_load_dwordx4 v[96:99], v236, s[24:27], s50 offen nt
    buffer_load_dwordx4 v[100:103], v237, s[24:27], s50 offen nt
    buffer_load_dwordx4 v[104:107], v238, s[24:27], s50 offen nt
    buffer_load_dwordx4 v[108:111], v239, s[24:27], s50 offen nt
    s_add_u32 s50, s60, 9216
    buffer_load_dwordx4 v[112:115], v236, s[24:27], s50 offen nt
    buffer_load_dwordx4 v[116:119], v237, s[24:27], s50 offen nt
    buffer_load_dwordx4 v[120:123], v238, s[24:27], s50 offen nt
    buffer_load_dwordx4 v[124:127], v239, s[24:27], s50 offen nt
    s_add_u32 s50, s60, 16384
    buffer_load_dwordx4 v[128:131], v236, s[24:27], s50 offen nt
    buffer_load_dwordx4 v[132:135], v237, s[24:27], s50 offen nt
    buffer_load_dwordx4 v[136:139], v238, s[24:27], s50 offen nt
    buffer_load_dwordx4 v[140:143], v239, s[24:27], s50 offen nt
    s_add_u32 s50, s60, 17408
    buffer_load_dwordx4 v[144:147], v236, s[24:27], s50 offen nt
    buffer_load_dwordx4 v[148:151], v237, s[24:27], s50 offen nt
    buffer_load_dwordx4 v[152:155], v238, s[24:27], s50 offen nt
    buffer_load_dwordx4 v[156:159], v239, s[24:27], s50 offen nt
    s_add_u32 s50, s60, 24576
    buffer_load_dwordx4 v[160:163], v236, s[24:27], s50 offen nt
    buffer_load_dwordx4 v[164:167], v237, s[24:27], s50 offen nt
    buffer_load_dwordx4 v[168:171], v238, s[24:27], s50 offen nt
    buffer_load_dwordx4 v[172:175], v239, s[24:27], s50 offen nt
K1_G1:
    s_add_u32 m0, s62, 0
    s_add_u32 s50, s57, 0
    buffer_load_dwordx4 v232, s[20:23], s50 offen lds
    s_add_u32 m0, s62, 1024
    s_add_u32 s50, s57, 4096
    buffer_load_dwordx4 v233, s[20:23], s50 offen lds
    s_add_u32 m0, s62, 2048
    s_add_u32 s50, s57, 8192
    buffer_load_dwordx4 v234, s[20:23], s50 offen lds
    s_add_u32 m0, s62, 3072
    s_add_u32 s50, s57, 12288
    buffer_load_dwordx4 v235, s[20:23], s50 offen lds
    s_add_u32 m0, s62, 4096
    s_add_u32 s50, s57, 16384
    buffer_load_dwordx4 v232, s[20:23], s50 offen lds
    s_add_u32 m0, s62, 5120
    s_add_u32 s50, s57, 20480
    buffer_load_dwordx4 v233, s[20:23], s50 offen lds
    s_lshl_b32 s54, s46, 16
    s_lshl_b32 s50, s45, 8
    s_add_u32 s54, s54, s50
    s_lshl_b32 s58, s46, 11
    s_add_u32 s58, s58, 98304
    s_mov_b32 s32, s10
    s_and_b32 s33, s11, 0xffff
    s_mov_b32 s34, 4194304
    s_mov_b32 s35, 0x00020000
    s_add_u32 m0, s58, 0
    s_nop 0
    buffer_load_dwordx4 v240, s[32:35], s54 offen lds
    s_add_u32 s54, s54, 32768
    s_add_u32 m0, s58, 1024
    s_nop 0
    buffer_load_dwordx4 v240, s[32:35], s54 offen lds
    s_add_u32 s54, s54, 229376
    s_add_u32 m0, s58, 8192
    s_nop 0
    buffer_load_dwordx4 v240, s[32:35], s54 offen lds
    s_add_u32 s54, s54, 32768
    s_add_u32 m0, s58, 9216
    s_nop 0
    buffer_load_dwordx4 v240, s[32:35], s54 offen lds
    s_add_u32 s54, s54, 229376
    s_add_u32 m0, s58, 16384
    s_nop 0
    buffer_load_dwordx4 v240, s[32:35], s54 offen lds
    s_add_u32 s54, s54, 32768
    s_add_u32 m0, s58, 17408
    s_nop 0
    buffer_load_dwordx4 v240, s[32:35], s54 offen lds
    s_add_u32 s54, s54, 229376
    s_add_u32 m0, s58, 24576
    s_nop 0
    buffer_load_dwordx4 v240, s[32:35], s54 offen lds
    s_add_u32 s54, s54, 32768
    s_add_u32 m0, s58, 25600
    s_nop 0
    buffer_load_dwordx4 v240, s[32:35], s54 offen lds
    s_add_u32 s54, s54, 229376
    s_add_u32 m0, s62, 24576
    s_add_u32 s50, s57, 256
    buffer_load_dwordx4 v232, s[20:23], s50 offen lds
    s_add_u32 m0, s62, 25600
    s_add_u32 s50, s57, 4352
    buffer_load_dwordx4 v233, s[20:23], s50 offen lds
    s_add_u32 m0, s62, 26624
    s_add_u32 s50, s57, 8448
    buffer_load_dwordx4 v234, s[20:23], s50 offen lds
    s_add_u32 m0, s62, 27648
    s_add_u32 s50, s57, 12544
    buffer_load_dwordx4 v235, s[20:23], s50 offen lds
    s_add_u32 m0, s62, 28672
    s_add_u32 s50, s57, 16640
    buffer_load_dwordx4 v232, s[20:23], s50 offen lds
    s_add_u32 m0, s62, 29696
    s_add_u32 s50, s57, 20736
    buffer_load_dwordx4 v233, s[20:23], s50 offen lds
    s_add_u32 m0, s58, 32768
    s_nop 0
    buffer_load_dwordx4 v240, s[32:35], s54 offen lds
    s_add_u32 s54, s54, 32768
    s_add_u32 m0, s58, 33792
    s_nop 0
    buffer_load_dwordx4 v240, s[32:35], s54 offen lds
    s_add_u32 s54, s54, 229376
    s_add_u32 m0, s58, 40960
    s_nop 0
    buffer_load_dwordx4 v240, s[32:35], s54 offen lds
    s_add_u32 s54, s54, 32768
    s_add_u32 m0, s58, 41984
    s_nop 0
    buffer_load_dwordx4 v240, s[32:35], s54 offen lds
    s_add_u32 s54, s54, 229376
    s_mov_b32 s36, s12
    s_and_b32 s37, s13, 0xffff
    s_mov_b32 s38, 4194304
    s_mov_b32 s39, 0x00020000
    s_mov_b32 s40, s18
    s_and_b32 s41, s19, 0xffff
    s_mov_b32 s42, 268435456
    s_mov_b32 s43, 0x00020000
    s_mov_b32 s48, 0x05040100
    s_mov_b32 s49, 0x07060302
    v_add_u32 v229, s58, v255
    v_lshlrev_b32 v39, 15, v36
    v_lshl_add_u32 v230, v35, 3, v39
    v_lshrrev_b32 v39, 3, v35
    v_lshlrev_b32 v39, 18, v39
    v_lshl_add_u32 v39, v36, 11, v39
    v_and_b32 v42, 1, v35
    v_lshl_add_u32 v39, v42, 10, v39
    v_bfe_u32 v42, v35, 1, 2
    v_lshl_add_u32 v231, v42, 6, v39
    s_waitcnt vmcnt(14)
    s_barrier
    s_waitcnt vmcnt(10)
    s_barrier
    s_add_u32 m0, s58, 49152
    s_nop 0
    buffer_load_dwordx4 v240, s[32:35], s54 offen lds
    s_add_u32 s54, s54, 32768
    s_add_u32 m0, s58, 50176
    s_nop 0
    buffer_load_dwordx4 v240, s[32:35], s54 offen lds
    s_add_u32 s54, s54, 229376
    s_add_u32 m0, s58, 57344
    s_nop 0
    buffer_load_dwordx4 v240, s[32:35], s54 offen lds
    s_add_u32 s54, s54, 32768
    s_add_u32 m0, s58, 58368
    s_nop 0
    buffer_load_dwordx4 v240, s[32:35], s54 offen lds
    s_add_u32 s54, s54, 229376
    s_waitcnt vmcnt(4)
    s_barrier
    s_add_u32 m0, s62, 49152
    s_add_u32 s50, s57, 512
    buffer_load_dwordx4 v232, s[20:23], s50 offen lds
    s_add_u32 m0, s62, 50176
    s_add_u32 s50, s57, 4608
    buffer_load_dwordx4 v233, s[20:23], s50 offen lds
    s_add_u32 m0, s62, 51200
    s_add_u32 s50, s57, 8704
    buffer_load_dwordx4 v234, s[20:23], s50 offen lds
    s_add_u32 m0, s62, 52224
    s_add_u32 s50, s57, 12800
    buffer_load_dwordx4 v235, s[20:23], s50 offen lds
    s_add_u32 m0, s62, 53248
    s_add_u32 s50, s57, 16896
    buffer_load_dwordx4 v232, s[20:23], s50 offen lds
    s_add_u32 m0, s62, 54272
    s_add_u32 s50, s57, 20992
    buffer_load_dwordx4 v233, s[20:23], s50 offen lds
    s_add_u32 m0, s58, 0
    s_nop 0
    buffer_load_dwordx4 v240, s[32:35], s54 offen lds
    s_add_u32 s54, s54, 32768
    s_add_u32 m0, s58, 1024
    s_nop 0
    buffer_load_dwordx4 v240, s[32:35], s54 offen lds
    s_add_u32 s54, s54, 229376
    s_add_u32 m0, s58, 8192
    s_nop 0
    buffer_load_dwordx4 v240, s[32:35], s54 offen lds
    s_add_u32 s54, s54, 32768
    s_add_u32 m0, s58, 9216
    s_nop 0
    buffer_load_dwordx4 v240, s[32:35], s54 offen lds
    s_add_u32 s54, s54, 229376
    s_waitcnt vmcnt(10)
    s_barrier
    s_add_u32 m0, s58, 16384
    s_nop 0
    buffer_load_dwordx4 v240, s[32:35], s54 offen lds
    s_add_u32 s54, s54, 32768
    s_add_u32 m0, s58, 17408
    s_nop 0
    buffer_load_dwordx4 v240, s[32:35], s54 offen lds
    s_add_u32 s54, s54, 229376
    s_add_u32 m0, s58, 24576
    s_nop 0
    buffer_load_dwordx4 v240, s[32:35], s54 offen lds
    s_add_u32 s54, s54, 32768
    s_add_u32 m0, s58, 25600
    s_nop 0
    buffer_load_dwordx4 v240, s[32:35], s54 offen lds
    s_add_u32 s54, s54, 229376
    s_waitcnt vmcnt(4)
    s_barrier
    s_add_u32 m0, s62, 73728
    s_add_u32 s50, s57, 768
    buffer_load_dwordx4 v232, s[20:23], s50 offen lds
    s_add_u32 m0, s62, 74752
    s_add_u32 s50, s57, 4864
    buffer_load_dwordx4 v233, s[20:23], s50 offen lds
    s_add_u32 m0, s62, 75776
    s_add_u32 s50, s57, 8960
    buffer_load_dwordx4 v234, s[20:23], s50 offen lds
    s_add_u32 m0, s62, 76800
    s_add_u32 s50, s57, 13056
    buffer_load_dwordx4 v235, s[20:23], s50 offen lds
    s_add_u32 m0, s62, 77824
    s_add_u32 s50, s57, 17152
    buffer_load_dwordx4 v232, s[20:23], s50 offen lds
    s_add_u32 m0, s62, 78848
    s_add_u32 s50, s57, 21248
    buffer_load_dwordx4 v233, s[20:23], s50 offen lds
    s_add_u32 m0, s58, 32768
    s_nop 0
    buffer_load_dwordx4 v240, s[32:35], s54 offen lds
    s_add_u32 s54, s54, 32768
    s_add_u32 m0, s58, 33792
    s_nop 0
    buffer_load_dwordx4 v240, s[32:35], s54 offen lds
    s_add_u32 s54, s54, 229376
    s_add_u32 m0, s58, 40960
    s_nop 0
    buffer_load_dwordx4 v240, s[32:35], s54 offen lds
    s_add_u32 s54, s54, 32768
    s_add_u32 m0, s58, 41984
    s_nop 0
    buffer_load_dwordx4 v240, s[32:35], s54 offen lds
    s_add_u32 s54, s54, 229376
    s_waitcnt vmcnt(10)
    s_barrier
    s_add_u32 m0, s58, 49152
    s_nop 0
    buffer_load_dwordx4 v240, s[32:35], s54 offen lds
    s_add_u32 s54, s54, 32768
    s_add_u32 m0, s58, 50176
    s_nop 0
    buffer_load_dwordx4 v240, s[32:35], s54 offen lds
    s_add_u32 s54, s54, 229376
    s_add_u32 m0, s58, 57344
    s_nop 0
    buffer_load_dwordx4 v240, s[32:35], s54 offen lds
    s_add_u32 s54, s54, 32768
    s_add_u32 m0, s58, 58368
    s_nop 0
    buffer_load_dwordx4 v240, s[32:35], s54 offen lds
    s_add_u32 s54, s54, 229376
    s_lshl_b32 s50, s45, 17
    s_add_u32 s50, s50, s59
    s_lshl_b32 s51, s44, 7
    s_add_u32 s50, s50, s51
    s_add_u32 s51, s50, 16384
    buffer_load_dwordx2 v[192:193], v230, s[36:39], s50 offen offset:0
    buffer_load_dwordx2 v[194:195], v230, s[36:39], s50 offen offset:1024
    buffer_load_dwordx2 v[196:197], v230, s[36:39], s50 offen offset:2048
    buffer_load_dwordx2 v[198:199], v230, s[36:39], s50 offen offset:3072
    buffer_load_dwordx2 v[200:201], v230, s[36:39], s51 offen offset:0
    buffer_load_dwordx2 v[202:203], v230, s[36:39], s51 offen offset:1024
    buffer_load_dwordx2 v[204:205], v230, s[36:39], s51 offen offset:2048
    buffer_load_dwordx2 v[206:207], v230, s[36:39], s51 offen offset:3072
    s_waitcnt vmcnt(12)
    s_barrier
    s_cmp_lg_u32 s63, 0
    s_cbranch_scc1 K1_G2
    s_add_u32 m0, s59, 98304
    s_add_u32 s50, s60, 0
    buffer_load_dwordx4 v236, s[24:27], s50 offen nt lds
    s_add_u32 m0, m0, 1024
    s_nop 0
    buffer_load_dwordx4 v237, s[24:27], s50 offen nt lds
    s_add_u32 m0, m0, 1024
    s_nop 0
    buffer_load_dwordx4 v238, s[24:27], s50 offen nt lds
    s_add_u32 m0, m0, 1024
    s_nop 0
    buffer_load_dwordx4 v239, s[24:27], s50 offen nt lds
K1_G2:
    s_cmp_lg_u32 s63, 1
    s_cbranch_scc1 K1_G3
    ds_write_b128 v228, v[64:67] offset:0
    ds_write_b128 v228, v[68:71] offset:1024
    ds_write_b128 v228, v[72:75] offset:2048
    ds_write_b128 v228, v[76:79] offset:3072
    s_waitcnt lgkmcnt(0)
K1_G3:
    s_cmp_lg_u32 s63, 1
    s_cbranch_scc1 K1_G4
    s_add_u32 s50, s61, 0
    buffer_load_dwordx4 v[64:67], v241, s[28:31], s50 offen offset:0 nt
    s_add_u32 s50, s61, 0
    buffer_load_dwordx4 v[68:71], v241, s[28:31], s50 offen offset:1024 nt
    s_add_u32 s50, s61, 32768
    buffer_load_dwordx4 v[72:75], v241, s[28:31], s50 offen offset:0 nt
    s_add_u32 s50, s61, 32768
    buffer_load_dwordx4 v[76:79], v241, s[28:31], s50 offen offset:1024 nt
K1_G4:
    s_waitcnt vmcnt(12)
    s_barrier
    s_cmp_lg_u32 s63, 0
    s_cbranch_scc1 K1_G5
    s_add_u32 m0, s59, 114688
    s_add_u32 s50, s60, 1024
    buffer_load_dwordx4 v236, s[24:27], s50 offen nt lds
    s_add_u32 m0, m0, 1024
    s_nop 0
    buffer_load_dwordx4 v237, s[24:27], s50 offen nt lds
    s_add_u32 m0, m0, 1024
    s_nop 0
    buffer_load_dwordx4 v238, s[24:27], s50 offen nt lds
    s_add_u32 m0, m0, 1024
    s_nop 0
    buffer_load_dwordx4 v239, s[24:27], s50 offen nt lds
K1_G5:
    s_cmp_lg_u32 s63, 1
    s_cbranch_scc1 K1_G6
    ds_write_b128 v228, v[80:83] offset:16384
    ds_write_b128 v228, v[84:87] offset:17408
    ds_write_b128 v228, v[88:91] offset:18432
    ds_write_b128 v228, v[92:95] offset:19456
    s_waitcnt lgkmcnt(0)
K1_G6:
    s_cmp_lg_u32 s63, 1
    s_cbranch_scc1 K1_G7
    s_add_u32 s50, s61, 65536
    buffer_load_dwordx4 v[80:83], v241, s[28:31], s50 offen offset:0 nt
    s_add_u32 s50, s61, 65536
    buffer_load_dwordx4 v[84:87], v241, s[28:31], s50 offen offset:1024 nt
    s_add_u32 s50, s61, 98304
    buffer_load_dwordx4 v[88:91], v241, s[28:31], s50 offen offset:0 nt
    s_add_u32 s50, s61, 98304
    buffer_load_dwordx4 v[92:95], v241, s[28:31], s50 offen offset:1024 nt
K1_G7:
    s_waitcnt vmcnt(16)
    s_barrier
    s_cmp_lg_u32 s63, 0
    s_cbranch_scc1 K1_G8
    s_add_u32 m0, s59, 131072
    s_add_u32 s50, s60, 8192
    buffer_load_dwordx4 v236, s[24:27], s50 offen nt lds
    s_add_u32 m0, m0, 1024
    s_nop 0
    buffer_load_dwordx4 v237, s[24:27], s50 offen nt lds
    s_add_u32 m0, m0, 1024
    s_nop 0
    buffer_load_dwordx4 v238, s[24:27], s50 offen nt lds
    s_add_u32 m0, m0, 1024
    s_nop 0
    buffer_load_dwordx4 v239, s[24:27], s50 offen nt lds
K1_G8:
    s_cmp_lg_u32 s63, 1
    s_cbranch_scc1 K1_G9
    ds_write_b128 v228, v[96:99] offset:32768
    ds_write_b128 v228, v[100:103] offset:33792
    ds_write_b128 v228, v[104:107] offset:34816
    ds_write_b128 v228, v[108:111] offset:35840
    s_waitcnt lgkmcnt(0)
K1_G9:
    s_cmp_lg_u32 s63, 1
    s_cbranch_scc1 K1_G10
    s_add_u32 s50, s61, 8192
    buffer_load_dwordx4 v[96:99], v241, s[28:31], s50 offen offset:0 nt
    s_add_u32 s50, s61, 8192
    buffer_load_dwordx4 v[100:103], v241, s[28:31], s50 offen offset:1024 nt
    s_add_u32 s50, s61, 40960
    buffer_load_dwordx4 v[104:107], v241, s[28:31], s50 offen offset:0 nt
    s_add_u32 s50, s61, 40960
    buffer_load_dwordx4 v[108:111], v241, s[28:31], s50 offen offset:1024 nt
K1_G10:
    s_barrier
    s_cmp_lg_u32 s63, 0
    s_cbranch_scc1 K1_G11
    s_add_u32 m0, s59, 24576
    s_add_u32 s50, s60, 9216
    buffer_load_dwordx4 v236, s[24:27], s50 offen nt lds
    s_add_u32 m0, m0, 1024
    s_nop 0
    buffer_load_dwordx4 v237, s[24:27], s50 offen nt lds
    s_add_u32 m0, m0, 1024
    s_nop 0
    buffer_load_dwordx4 v238, s[24:27], s50 offen nt lds
    s_add_u32 m0, m0, 1024
    s_nop 0
    buffer_load_dwordx4 v239, s[24:27], s50 offen nt lds
K1_G11:
    s_cmp_lg_u32 s63, 1
    s_cbranch_scc1 K1_G12
    ds_write_b128 v227, v[112:115] offset:0
    ds_write_b128 v227, v[116:119] offset:1024
    ds_write_b128 v227, v[120:123] offset:2048
    ds_write_b128 v227, v[124:127] offset:3072
    s_waitcnt lgkmcnt(0)
K1_G12:
    s_cmp_lg_u32 s63, 0
    s_cbranch_scc1 K1_G13
    s_add_u32 m0, s59, 40960
    s_add_u32 s50, s60, 16384
    buffer_load_dwordx4 v236, s[24:27], s50 offen nt lds
    s_add_u32 m0, m0, 1024
    s_nop 0
    buffer_load_dwordx4 v237, s[24:27], s50 offen nt lds
    s_add_u32 m0, m0, 1024
    s_nop 0
    buffer_load_dwordx4 v238, s[24:27], s50 offen nt lds
    s_add_u32 m0, m0, 1024
    s_nop 0
    buffer_load_dwordx4 v239, s[24:27], s50 offen nt lds
K1_G13:
    s_cmp_lg_u32 s63, 1
    s_cbranch_scc1 K1_G14
    ds_write_b128 v227, v[128:131] offset:16384
    ds_write_b128 v227, v[132:135] offset:17408
    ds_write_b128 v227, v[136:139] offset:18432
    ds_write_b128 v227, v[140:143] offset:19456
    s_waitcnt lgkmcnt(0)
K1_G14:
    s_cmp_lg_u32 s63, 1
    s_cbranch_scc1 K1_G15
    s_add_u32 s50, s61, 73728
    buffer_load_dwordx4 v[112:115], v241, s[28:31], s50 offen offset:0 nt
    s_add_u32 s50, s61, 73728
    buffer_load_dwordx4 v[116:119], v241, s[28:31], s50 offen offset:1024 nt
K1_G15:
    s_cmp_lg_u32 s63, 0
    s_cbranch_scc1 K1_G16
    s_waitcnt vmcnt(16)
K1_G16:
    s_waitcnt vmcnt(63)
    s_cmp_lg_u32 s63, 0
    s_cbranch_scc1 K1_G17
    s_waitcnt vmcnt(12)
K1_G17:
    s_waitcnt vmcnt(63)
    s_barrier
    s_cmp_lg_u32 s63, 0
    s_cbranch_scc1 K1_G18
    s_add_u32 m0, s59, 57344
    s_add_u32 s50, s60, 17408
    buffer_load_dwordx4 v236, s[24:27], s50 offen nt lds
    s_add_u32 m0, m0, 1024
    s_nop 0
    buffer_load_dwordx4 v237, s[24:27], s50 offen nt lds
    s_add_u32 m0, m0, 1024
    s_nop 0
    buffer_load_dwordx4 v238, s[24:27], s50 offen nt lds
    s_add_u32 m0, m0, 1024
    s_nop 0
    buffer_load_dwordx4 v239, s[24:27], s50 offen nt lds
K1_G18:
    s_cmp_lg_u32 s63, 1
    s_cbranch_scc1 K1_G19
    ds_write_b128 v227, v[144:147] offset:32768
    ds_write_b128 v227, v[148:151] offset:33792
    ds_write_b128 v227, v[152:155] offset:34816
    ds_write_b128 v227, v[156:159] offset:35840
    s_waitcnt lgkmcnt(0)
K1_G19:
    s_cmp_lg_u32 s63, 0
    s_cbranch_scc1 K1_G20
    s_add_u32 m0, s59, 73728
    s_add_u32 s50, s60, 24576
    buffer_load_dwordx4 v236, s[24:27], s50 offen nt lds
    s_add_u32 m0, m0, 1024
    s_nop 0
    buffer_load_dwordx4 v237, s[24:27], s50 offen nt lds
    s_add_u32 m0, m0, 1024
    s_nop 0
    buffer_load_dwordx4 v238, s[24:27], s50 offen nt lds
    s_add_u32 m0, m0, 1024
    s_nop 0
    buffer_load_dwordx4 v239, s[24:27], s50 offen nt lds
K1_G20:
    s_cmp_lg_u32 s63, 1
    s_cbranch_scc1 K1_G21
    ds_write_b128 v227, v[160:163] offset:49152
    ds_write_b128 v227, v[164:167] offset:50176
    ds_write_b128 v227, v[168:171] offset:51200
    ds_write_b128 v227, v[172:175] offset:52224
    s_waitcnt lgkmcnt(0)
K1_G21:
    s_cmp_lg_u32 s63, 1
    s_cbranch_scc1 K1_G22
    s_add_u32 s50, s61, 106496
    buffer_load_dwordx4 v[120:123], v241, s[28:31], s50 offen offset:0 nt
    s_add_u32 s50, s61, 106496
    buffer_load_dwordx4 v[124:127], v241, s[28:31], s50 offen offset:1024 nt
K1_G22:
    s_cmp_lg_u32 s63, 0
    s_cbranch_scc1 K1_G23
    s_waitcnt vmcnt(16)
K1_G23:
    s_waitcnt vmcnt(63)
    s_cmp_lg_u32 s63, 0
    s_cbranch_scc1 K1_G24
    s_waitcnt vmcnt(12)
K1_G24:
    s_waitcnt vmcnt(63)
    s_barrier
    s_add_u32 m0, s59, 98304
    s_add_u32 s50, s60, 25600
    buffer_load_dwordx4 v236, s[24:27], s50 offen nt lds
    s_add_u32 m0, m0, 1024
    s_nop 0
    buffer_load_dwordx4 v237, s[24:27], s50 offen nt lds
    s_add_u32 m0, m0, 1024
    s_nop 0
    buffer_load_dwordx4 v238, s[24:27], s50 offen nt lds
    s_add_u32 m0, m0, 1024
    s_nop 0
    buffer_load_dwordx4 v239, s[24:27], s50 offen nt lds
    s_cmp_lg_u32 s63, 0
    s_cbranch_scc1 K1_G25
    s_add_u32 s50, s61, 0
    buffer_load_dwordx4 v[64:67], v241, s[28:31], s50 offen offset:0 nt
    s_add_u32 s50, s61, 0
    buffer_load_dwordx4 v[68:71], v241, s[28:31], s50 offen offset:1024 nt
    s_add_u32 s50, s61, 32768
    buffer_load_dwordx4 v[72:75], v241, s[28:31], s50 offen offset:0 nt
    s_add_u32 s50, s61, 32768
    buffer_load_dwordx4 v[76:79], v241, s[28:31], s50 offen offset:1024 nt
K1_G25:
    s_cmp_lg_u32 s63, 1
    s_cbranch_scc1 K1_G26
    s_add_u32 s50, s61, 16384
    buffer_load_dwordx4 v[128:131], v241, s[28:31], s50 offen offset:0 nt
    s_add_u32 s50, s61, 16384
    buffer_load_dwordx4 v[132:135], v241, s[28:31], s50 offen offset:1024 nt
    s_add_u32 s50, s61, 49152
    buffer_load_dwordx4 v[136:139], v241, s[28:31], s50 offen offset:0 nt
    s_add_u32 s50, s61, 49152
    buffer_load_dwordx4 v[140:143], v241, s[28:31], s50 offen offset:1024 nt
K1_G26:
    s_cmp_lg_u32 s63, 0
    s_cbranch_scc1 K1_G27
    s_waitcnt vmcnt(16)
K1_G27:
    s_waitcnt vmcnt(63)
    s_cmp_lg_u32 s63, 0
    s_cbranch_scc1 K1_G28
    s_waitcnt vmcnt(12)
K1_G28:
    s_waitcnt vmcnt(63)
    s_barrier
    s_cmp_lg_u32 s63, 0
    s_cbranch_scc1 K1_G29
    s_add_u32 s50, s61, 65536
    buffer_load_dwordx4 v[80:83], v241, s[28:31], s50 offen offset:0 nt
    s_add_u32 s50, s61, 65536
    buffer_load_dwordx4 v[84:87], v241, s[28:31], s50 offen offset:1024 nt
    s_add_u32 s50, s61, 98304
    buffer_load_dwordx4 v[88:91], v241, s[28:31], s50 offen offset:0 nt
    s_add_u32 s50, s61, 98304
    buffer_load_dwordx4 v[92:95], v241, s[28:31], s50 offen offset:1024 nt
    s_add_u32 s50, s61, 8192
    buffer_load_dwordx4 v[96:99], v241, s[28:31], s50 offen offset:0 nt
    s_add_u32 s50, s61, 8192
    buffer_load_dwordx4 v[100:103], v241, s[28:31], s50 offen offset:1024 nt
K1_G29:
    s_cmp_lg_u32 s63, 1
    s_cbranch_scc1 K1_G30
    s_add_u32 s50, s61, 81920
    buffer_load_dwordx4 v[144:147], v241, s[28:31], s50 offen offset:0 nt
    s_add_u32 s50, s61, 81920
    buffer_load_dwordx4 v[148:151], v241, s[28:31], s50 offen offset:1024 nt
    s_add_u32 s50, s61, 114688
    buffer_load_dwordx4 v[152:155], v241, s[28:31], s50 offen offset:0 nt
    s_add_u32 s50, s61, 114688
    buffer_load_dwordx4 v[156:159], v241, s[28:31], s50 offen offset:1024 nt
K1_G30:
    s_cmp_lg_u32 s63, 0
    s_cbranch_scc1 K1_G31
    s_waitcnt vmcnt(14)
K1_G31:
    s_waitcnt vmcnt(63)
    s_cmp_lg_u32 s63, 1
    s_cbranch_scc1 K1_G32
    s_waitcnt vmcnt(8)
K1_G32:
    s_waitcnt vmcnt(10)
    s_barrier
    s_cmp_lg_u32 s63, 0
    s_cbranch_scc1 K1_G33
    s_add_u32 s50, s61, 40960
    buffer_load_dwordx4 v[104:107], v241, s[28:31], s50 offen offset:0 nt
    s_add_u32 s50, s61, 40960
    buffer_load_dwordx4 v[108:111], v241, s[28:31], s50 offen offset:1024 nt
    s_add_u32 s50, s61, 73728
    buffer_load_dwordx4 v[112:115], v241, s[28:31], s50 offen offset:0 nt
    s_add_u32 s50, s61, 73728
    buffer_load_dwordx4 v[116:119], v241, s[28:31], s50 offen offset:1024 nt
K1_G33:
    s_cmp_lg_u32 s63, 1
    s_cbranch_scc1 K1_G34
    s_add_u32 s50, s61, 24576
    buffer_load_dwordx4 v[160:163], v241, s[28:31], s50 offen offset:0 nt
    s_add_u32 s50, s61, 24576
    buffer_load_dwordx4 v[164:167], v241, s[28:31], s50 offen offset:1024 nt
    s_add_u32 s50, s61, 57344
    buffer_load_dwordx4 v[168:171], v241, s[28:31], s50 offen offset:0 nt
    s_add_u32 s50, s61, 57344
    buffer_load_dwordx4 v[172:175], v241, s[28:31], s50 offen offset:1024 nt
K1_G34:
    s_barrier
    s_cmp_lg_u32 s63, 0
    s_cbranch_scc1 K1_G35
    s_add_u32 s50, s61, 106496
    buffer_load_dwordx4 v[120:123], v241, s[28:31], s50 offen offset:0 nt
    s_add_u32 s50, s61, 106496
    buffer_load_dwordx4 v[124:127], v241, s[28:31], s50 offen offset:1024 nt
    s_add_u32 s50, s61, 16384
    buffer_load_dwordx4 v[128:131], v241, s[28:31], s50 offen offset:0 nt
    s_add_u32 s50, s61, 16384
    buffer_load_dwordx4 v[132:135], v241, s[28:31], s50 offen offset:1024 nt
    s_add_u32 s50, s61, 49152
    buffer_load_dwordx4 v[136:139], v241, s[28:31], s50 offen offset:0 nt
    s_add_u32 s50, s61, 49152
    buffer_load_dwordx4 v[140:143], v241, s[28:31], s50 offen offset:1024 nt
K1_G35:
    s_cmp_lg_u32 s63, 1
    s_cbranch_scc1 K1_G36
    s_add_u32 s50, s61, 90112
    buffer_load_dwordx4 v[176:179], v241, s[28:31], s50 offen offset:0 nt
    s_add_u32 s50, s61, 90112
    buffer_load_dwordx4 v[180:183], v241, s[28:31], s50 offen offset:1024 nt
    s_add_u32 s50, s61, 122880
    buffer_load_dwordx4 v[184:187], v241, s[28:31], s50 offen offset:0 nt
    s_add_u32 s50, s61, 122880
    buffer_load_dwordx4 v[188:191], v241, s[28:31], s50 offen offset:1024 nt
K1_G36:
    s_cmp_lg_u32 s63, 0
    s_cbranch_scc1 K1_G37
    s_waitcnt vmcnt(16)
K1_G37:
    s_waitcnt vmcnt(32)
    ds_write_b128 v229, v[64:67] offset:0
    ds_write_b128 v229, v[68:71] offset:1024
    ds_write_b128 v229, v[72:75] offset:8192
    ds_write_b128 v229, v[76:79] offset:9216
    s_cmp_lg_u32 s63, 0
    s_cbranch_scc1 K1_G38
    s_waitcnt vmcnt(12)
K1_G38:
    s_waitcnt vmcnt(28)
    ds_write_b128 v229, v[80:83] offset:16384
    ds_write_b128 v229, v[84:87] offset:17408
    ds_write_b128 v229, v[88:91] offset:24576
    ds_write_b128 v229, v[92:95] offset:25600
    s_waitcnt lgkmcnt(0)
    s_barrier
    s_cmp_lg_u32 s63, 0
    s_cbranch_scc1 K1_G39
    s_waitcnt vmcnt(8)
K1_G39:
    s_waitcnt vmcnt(24)
    ds_write_b128 v229, v[96:99] offset:32768
    ds_write_b128 v229, v[100:103] offset:33792
    ds_write_b128 v229, v[104:107] offset:40960
    ds_write_b128 v229, v[108:111] offset:41984
    s_cmp_lg_u32 s63, 0
    s_cbranch_scc1 K1_G40
    s_waitcnt vmcnt(4)
K1_G40:
    s_waitcnt vmcnt(20)
    ds_write_b128 v229, v[112:115] offset:49152
    ds_write_b128 v229, v[116:119] offset:50176
    ds_write_b128 v229, v[120:123] offset:57344
    ds_write_b128 v229, v[124:127] offset:58368
    s_cmp_lg_u32 s63, 0
    s_cbranch_scc1 K1_G41
    s_add_u32 s50, s61, 81920
    buffer_load_dwordx4 v[144:147], v241, s[28:31], s50 offen offset:0 nt
    s_add_u32 s50, s61, 81920
    buffer_load_dwordx4 v[148:151], v241, s[28:31], s50 offen offset:1024 nt
    s_add_u32 s50, s61, 114688
    buffer_load_dwordx4 v[152:155], v241, s[28:31], s50 offen offset:0 nt
    s_add_u32 s50, s61, 114688
    buffer_load_dwordx4 v[156:159], v241, s[28:31], s50 offen offset:1024 nt
    s_add_u32 s50, s61, 24576
    buffer_load_dwordx4 v[160:163], v241, s[28:31], s50 offen offset:0 nt
    s_add_u32 s50, s61, 24576
    buffer_load_dwordx4 v[164:167], v241, s[28:31], s50 offen offset:1024 nt
K1_G41:
    s_waitcnt lgkmcnt(0)
    s_barrier
    s_cmp_lg_u32 s63, 0
    s_cbranch_scc1 K1_G42
    s_waitcnt vmcnt(6)
K1_G42:
    s_waitcnt vmcnt(12)
    ds_write_b128 v229, v[128:131] offset:0
    ds_write_b128 v229, v[132:135] offset:1024
    ds_write_b128 v229, v[136:139] offset:8192
    ds_write_b128 v229, v[140:143] offset:9216
    s_cmp_lg_u32 s63, 0
    s_cbranch_scc1 K1_G43
    s_waitcnt vmcnt(2)
K1_G43:
    s_waitcnt vmcnt(8)
    ds_write_b128 v229, v[144:147] offset:16384
    ds_write_b128 v229, v[148:151] offset:17408
    ds_write_b128 v229, v[152:155] offset:24576
    ds_write_b128 v229, v[156:159] offset:25600
    s_cmp_lg_u32 s63, 0
    s_cbranch_scc1 K1_G44
    s_add_u32 s50, s61, 57344
    buffer_load_dwordx4 v[168:171], v241, s[28:31], s50 offen offset:0 nt
    s_add_u32 s50, s61, 57344
    buffer_load_dwordx4 v[172:175], v241, s[28:31], s50 offen offset:1024 nt
    s_add_u32 s50, s61, 90112
    buffer_load_dwordx4 v[176:179], v241, s[28:31], s50 offen offset:0 nt
    s_add_u32 s50, s61, 90112
    buffer_load_dwordx4 v[180:183], v241, s[28:31], s50 offen offset:1024 nt
    s_add_u32 s50, s61, 122880
    buffer_load_dwordx4 v[184:187], v241, s[28:31], s50 offen offset:0 nt
    s_add_u32 s50, s61, 122880
    buffer_load_dwordx4 v[188:191], v241, s[28:31], s50 offen offset:1024 nt
K1_G44:
    s_waitcnt lgkmcnt(0)
    s_barrier
    s_waitcnt vmcnt(4)
    ds_write_b128 v229, v[160:163] offset:32768
    ds_write_b128 v229, v[164:167] offset:33792
    ds_write_b128 v229, v[168:171] offset:40960
    ds_write_b128 v229, v[172:175] offset:41984
    s_waitcnt vmcnt(0)
    ds_write_b128 v229, v[176:179] offset:49152
    ds_write_b128 v229, v[180:183] offset:50176
    ds_write_b128 v229, v[184:187] offset:57344
    ds_write_b128 v229, v[188:191] offset:58368
    s_waitcnt lgkmcnt(0)
    s_barrier
    s_lshl_b32 s50, s44, 6
    s_add_u32 s50, s50, s45
    s_lshl_b32 s50, s50, 13
    s_lshl_b32 s51, s46, 8
    s_add_u32 s50, s50, s51
    s_add_u32 s50, s50, 8388608
    s_cmp_lg_u32 s63, 1
    s_cbranch_scc1 K1_G45
    s_waitcnt vmcnt(36)
K1_G45:
    s_waitcnt vmcnt(63)
    v_perm_b32 v208, v194, v192, s48
    v_perm_b32 v209, v198, v196, s48
    v_perm_b32 v210, v202, v200, s48
    v_perm_b32 v211, v206, v204, s48
    v_perm_b32 v212, v194, v192, s49
    v_perm_b32 v213, v198, v196, s49
    v_perm_b32 v214, v202, v200, s49
    v_perm_b32 v215, v206, v204, s49
    v_perm_b32 v216, v195, v193, s48
    v_perm_b32 v217, v199, v197, s48
    v_perm_b32 v218, v203, v201, s48
    v_perm_b32 v219, v207, v205, s48
    v_perm_b32 v220, v195, v193, s49
    v_perm_b32 v221, v199, v197, s49
    v_perm_b32 v222, v203, v201, s49
    v_perm_b32 v223, v207, v205, s49
    buffer_store_dwordx4 v[208:211], v231, s[40:43], s50 offen offset:0
    buffer_store_dwordx4 v[212:215], v231, s[40:43], s50 offen offset:16
    buffer_store_dwordx4 v[216:219], v231, s[40:43], s50 offen offset:32
    buffer_store_dwordx4 v[220:223], v231, s[40:43], s50 offen offset:48
K1_END:
    s_endpgm
.globl oproj_kernel
.p2align 8
.type oproj_kernel,@function
oproj_kernel:
    s_cmp_ge_u32 s2, 256
    s_cbranch_scc1 K2_END
    s_load_dwordx2 s[4:5], s[0:1], 40
    s_load_dwordx2 s[6:7], s[0:1], 56
    v_lshrrev_b32 v1, 6, v0
    v_and_b32 v2, 63, v0
    v_readfirstlane_b32 s46, v1
    v_lshlrev_b32 v104, 4, v2
    s_and_b32 s50, s2, 7
    s_lshr_b32 s51, s2, 3
    s_lshr_b32 s44, s50, 1
    s_mul_i32 s44, s44, 12
    s_lshr_b32 s52, s51, 3
    s_mul_i32 s52, s52, 3
    s_add_u32 s44, s44, s52
    s_and_b32 s45, s50, 1
    s_lshl_b32 s45, s45, 3
    s_and_b32 s52, s51, 7
    s_mul_i32 s52, s52, 1
    s_add_u32 s45, s45, s52
    s_mul_i32 s52, s46, 98304
    s_add_u32 s53, s44, 0
    s_mul_hi_u32 s54, s53, 0x55555556
    s_mul_i32 s55, s54, 3
    s_sub_u32 s55, s53, s55
    s_mul_i32 s54, s54, 393216
    s_lshl_b32 s55, s55, 10
    s_add_u32 s54, s54, s55
    s_add_u32 s60, s54, s52
    s_add_u32 s53, s44, 1
    s_mul_hi_u32 s54, s53, 0x55555556
    s_mul_i32 s55, s54, 3
    s_sub_u32 s55, s53, s55
    s_mul_i32 s54, s54, 393216
    s_lshl_b32 s55, s55, 10
    s_add_u32 s54, s54, s55
    s_add_u32 s61, s54, s52
    s_add_u32 s53, s44, 2
    s_mul_hi_u32 s54, s53, 0x55555556
    s_mul_i32 s55, s54, 3
    s_sub_u32 s55, s53, s55
    s_mul_i32 s54, s54, 393216
    s_lshl_b32 s55, s55, 10
    s_add_u32 s54, s54, s55
    s_add_u32 s62, s54, s52
    s_lshl_b32 s54, s45, 18
    s_lshl_b32 s55, s46, 16
    s_add_u32 s54, s54, s55
    s_add_u32 s64, s54, 8388608
    v_and_b32 v3, 15, v2
    v_lshrrev_b32 v4, 4, v2
    v_lshlrev_b32 v4, 4, v4
    v_lshl_add_u32 v105, v3, 10, v4
    s_mul_i32 s52, s46, 6144
    v_add_u32 v106, s52, v104
    s_mul_i32 s52, s46, 2048
    v_add_u32 v107, s52, v104
    s_waitcnt lgkmcnt(0)
    s_mov_b32 s20, s6
    s_and_b32 s21, s7, 0xffff
    s_mov_b32 s22, 268435456
    s_mov_b32 s23, 0x00020000
    buffer_load_dwordx4 v[0:3], v104, s[20:23], s64 offen offset:0
    buffer_load_dwordx4 v[4:7], v104, s[20:23], s64 offen offset:1024
    s_add_u32 s64, s64, 2048
    buffer_load_dwordx4 v[8:11], v104, s[20:23], s60 offen
    s_add_u32 s60, s60, 3072
    buffer_load_dwordx4 v[12:15], v104, s[20:23], s61 offen
    s_add_u32 s61, s61, 3072
    buffer_load_dwordx4 v[16:19], v104, s[20:23], s62 offen
    s_add_u32 s62, s62, 3072
    buffer_load_dwordx4 v[20:23], v104, s[20:23], s64 offen offset:0
    buffer_load_dwordx4 v[24:27], v104, s[20:23], s64 offen offset:1024
    s_add_u32 s64, s64, 2048
    buffer_load_dwordx4 v[28:31], v104, s[20:23], s60 offen
    s_add_u32 s60, s60, 3072
    buffer_load_dwordx4 v[32:35], v104, s[20:23], s61 offen
    s_add_u32 s61, s61, 3072
    buffer_load_dwordx4 v[36:39], v104, s[20:23], s62 offen
    s_add_u32 s62, s62, 3072
    buffer_load_dwordx4 v[40:43], v104, s[20:23], s64 offen offset:0
    buffer_load_dwordx4 v[44:47], v104, s[20:23], s64 offen offset:1024
    s_add_u32 s64, s64, 2048
    buffer_load_dwordx4 v[48:51], v104, s[20:23], s60 offen
    s_add_u32 s60, s60, 3072
    buffer_load_dwordx4 v[52:55], v104, s[20:23], s61 offen
    s_add_u32 s61, s61, 3072
    buffer_load_dwordx4 v[56:59], v104, s[20:23], s62 offen
    s_add_u32 s62, s62, 3072
    buffer_load_dwordx4 v[60:63], v104, s[20:23], s64 offen offset:0
    buffer_load_dwordx4 v[64:67], v104, s[20:23], s64 offen offset:1024
    s_add_u32 s64, s64, 2048
    buffer_load_dwordx4 v[68:71], v104, s[20:23], s60 offen
    s_add_u32 s60, s60, 3072
    buffer_load_dwordx4 v[72:75], v104, s[20:23], s61 offen
    s_add_u32 s61, s61, 3072
    buffer_load_dwordx4 v[76:79], v104, s[20:23], s62 offen
    s_add_u32 s62, s62, 3072
    s_mov_b32 s24, s4
    s_and_b32 s25, s5, 0xffff
    s_mov_b32 s26, 786432
    s_mov_b32 s27, 0x00020000
    v_mov_b32 v80, 0
    v_mov_b32 v81, 0
    v_mov_b32 v82, 0
    v_mov_b32 v83, 0
    v_mov_b32 v84, 0
    v_mov_b32 v85, 0
    v_mov_b32 v86, 0
    v_mov_b32 v87, 0
    v_mov_b32 v88, 0
    v_mov_b32 v89, 0
    v_mov_b32 v90, 0
    v_mov_b32 v91, 0
    v_mov_b32 v92, 0
    v_mov_b32 v93, 0
    v_mov_b32 v94, 0
    v_mov_b32 v95, 0
    v_mov_b32 v96, 0
    v_mov_b32 v97, 0
    v_mov_b32 v98, 0
    v_mov_b32 v99, 0
    v_mov_b32 v100, 0
    v_mov_b32 v101, 0
    v_mov_b32 v102, 0
    v_mov_b32 v103, 0
    s_mov_b32 s58, 7
K2_LOOP:
    s_waitcnt vmcnt(15)
    v_mfma_f32_16x16x32_bf16 v[80:83], v[0:3], v[8:11], v[80:83]
    v_mfma_f32_16x16x32_bf16 v[84:87], v[4:7], v[8:11], v[84:87]
    v_mfma_f32_16x16x32_bf16 v[88:91], v[0:3], v[12:15], v[88:91]
    v_mfma_f32_16x16x32_bf16 v[92:95], v[4:7], v[12:15], v[92:95]
    v_mfma_f32_16x16x32_bf16 v[96:99], v[0:3], v[16:19], v[96:99]
    v_mfma_f32_16x16x32_bf16 v[100:103], v[4:7], v[16:19], v[100:103]
    buffer_load_dwordx4 v[0:3], v104, s[20:23], s64 offen offset:0
    buffer_load_dwordx4 v[4:7], v104, s[20:23], s64 offen offset:1024
    s_add_u32 s64, s64, 2048
    buffer_load_dwordx4 v[8:11], v104, s[20:23], s60 offen
    s_add_u32 s60, s60, 3072
    buffer_load_dwordx4 v[12:15], v104, s[20:23], s61 offen
    s_add_u32 s61, s61, 3072
    buffer_load_dwordx4 v[16:19], v104, s[20:23], s62 offen
    s_add_u32 s62, s62, 3072
    s_waitcnt vmcnt(15)
    v_mfma_f32_16x16x32_bf16 v[80:83], v[20:23], v[28:31], v[80:83]
    v_mfma_f32_16x16x32_bf16 v[84:87], v[24:27], v[28:31], v[84:87]
    v_mfma_f32_16x16x32_bf16 v[88:91], v[20:23], v[32:35], v[88:91]
    v_mfma_f32_16x16x32_bf16 v[92:95], v[24:27], v[32:35], v[92:95]
    v_mfma_f32_16x16x32_bf16 v[96:99], v[20:23], v[36:39], v[96:99]
    v_mfma_f32_16x16x32_bf16 v[100:103], v[24:27], v[36:39], v[100:103]
    buffer_load_dwordx4 v[20:23], v104, s[20:23], s64 offen offset:0
    buffer_load_dwordx4 v[24:27], v104, s[20:23], s64 offen offset:1024
    s_add_u32 s64, s64, 2048
    buffer_load_dwordx4 v[28:31], v104, s[20:23], s60 offen
    s_add_u32 s60, s60, 3072
    buffer_load_dwordx4 v[32:35], v104, s[20:23], s61 offen
    s_add_u32 s61, s61, 3072
    buffer_load_dwordx4 v[36:39], v104, s[20:23], s62 offen
    s_add_u32 s62, s62, 3072
    s_waitcnt vmcnt(15)
    v_mfma_f32_16x16x32_bf16 v[80:83], v[40:43], v[48:51], v[80:83]
    v_mfma_f32_16x16x32_bf16 v[84:87], v[44:47], v[48:51], v[84:87]
    v_mfma_f32_16x16x32_bf16 v[88:91], v[40:43], v[52:55], v[88:91]
    v_mfma_f32_16x16x32_bf16 v[92:95], v[44:47], v[52:55], v[92:95]
    v_mfma_f32_16x16x32_bf16 v[96:99], v[40:43], v[56:59], v[96:99]
    v_mfma_f32_16x16x32_bf16 v[100:103], v[44:47], v[56:59], v[100:103]
    buffer_load_dwordx4 v[40:43], v104, s[20:23], s64 offen offset:0
    buffer_load_dwordx4 v[44:47], v104, s[20:23], s64 offen offset:1024
    s_add_u32 s64, s64, 2048
    buffer_load_dwordx4 v[48:51], v104, s[20:23], s60 offen
    s_add_u32 s60, s60, 3072
    buffer_load_dwordx4 v[52:55], v104, s[20:23], s61 offen
    s_add_u32 s61, s61, 3072
    buffer_load_dwordx4 v[56:59], v104, s[20:23], s62 offen
    s_add_u32 s62, s62, 3072
    s_waitcnt vmcnt(15)
    v_mfma_f32_16x16x32_bf16 v[80:83], v[60:63], v[68:71], v[80:83]
    v_mfma_f32_16x16x32_bf16 v[84:87], v[64:67], v[68:71], v[84:87]
    v_mfma_f32_16x16x32_bf16 v[88:91], v[60:63], v[72:75], v[88:91]
    v_mfma_f32_16x16x32_bf16 v[92:95], v[64:67], v[72:75], v[92:95]
    v_mfma_f32_16x16x32_bf16 v[96:99], v[60:63], v[76:79], v[96:99]
    v_mfma_f32_16x16x32_bf16 v[100:103], v[64:67], v[76:79], v[100:103]
    buffer_load_dwordx4 v[60:63], v104, s[20:23], s64 offen offset:0
    buffer_load_dwordx4 v[64:67], v104, s[20:23], s64 offen offset:1024
    s_add_u32 s64, s64, 2048
    buffer_load_dwordx4 v[68:71], v104, s[20:23], s60 offen
    s_add_u32 s60, s60, 3072
    buffer_load_dwordx4 v[72:75], v104, s[20:23], s61 offen
    s_add_u32 s61, s61, 3072
    buffer_load_dwordx4 v[76:79], v104, s[20:23], s62 offen
    s_add_u32 s62, s62, 3072
    s_sub_u32 s58, s58, 1
    s_cmp_lg_u32 s58, 0
    s_cbranch_scc1 K2_LOOP
    s_waitcnt vmcnt(15)
    v_mfma_f32_16x16x32_bf16 v[80:83], v[0:3], v[8:11], v[80:83]
    v_mfma_f32_16x16x32_bf16 v[84:87], v[4:7], v[8:11], v[84:87]
    v_mfma_f32_16x16x32_bf16 v[88:91], v[0:3], v[12:15], v[88:91]
    v_mfma_f32_16x16x32_bf16 v[92:95], v[4:7], v[12:15], v[92:95]
    v_mfma_f32_16x16x32_bf16 v[96:99], v[0:3], v[16:19], v[96:99]
    v_mfma_f32_16x16x32_bf16 v[100:103], v[4:7], v[16:19], v[100:103]
    s_waitcnt vmcnt(10)
    v_mfma_f32_16x16x32_bf16 v[80:83], v[20:23], v[28:31], v[80:83]
    v_mfma_f32_16x16x32_bf16 v[84:87], v[24:27], v[28:31], v[84:87]
    v_mfma_f32_16x16x32_bf16 v[88:91], v[20:23], v[32:35], v[88:91]
    v_mfma_f32_16x16x32_bf16 v[92:95], v[24:27], v[32:35], v[92:95]
    v_mfma_f32_16x16x32_bf16 v[96:99], v[20:23], v[36:39], v[96:99]
    v_mfma_f32_16x16x32_bf16 v[100:103], v[24:27], v[36:39], v[100:103]
    s_waitcnt vmcnt(5)
    v_mfma_f32_16x16x32_bf16 v[80:83], v[40:43], v[48:51], v[80:83]
    v_mfma_f32_16x16x32_bf16 v[84:87], v[44:47], v[48:51], v[84:87]
    v_mfma_f32_16x16x32_bf16 v[88:91], v[40:43], v[52:55], v[88:91]
    v_mfma_f32_16x16x32_bf16 v[92:95], v[44:47], v[52:55], v[92:95]
    v_mfma_f32_16x16x32_bf16 v[96:99], v[40:43], v[56:59], v[96:99]
    v_mfma_f32_16x16x32_bf16 v[100:103], v[44:47], v[56:59], v[100:103]
    s_waitcnt vmcnt(0)
    v_mfma_f32_16x16x32_bf16 v[80:83], v[60:63], v[68:71], v[80:83]
    v_mfma_f32_16x16x32_bf16 v[84:87], v[64:67], v[68:71], v[84:87]
    v_mfma_f32_16x16x32_bf16 v[88:91], v[60:63], v[72:75], v[88:91]
    v_mfma_f32_16x16x32_bf16 v[92:95], v[64:67], v[72:75], v[92:95]
    v_mfma_f32_16x16x32_bf16 v[96:99], v[60:63], v[76:79], v[96:99]
    v_mfma_f32_16x16x32_bf16 v[100:103], v[64:67], v[76:79], v[100:103]
    s_add_u32 s52, s44, s46
    s_lshl_b32 s52, s52, 14
    s_lshl_b32 s53, s45, 6
    s_add_u32 s52, s52, s53
    s_nop 7
    ds_write_b128 v106, v[80:83] offset:0
    ds_write_b128 v106, v[84:87] offset:1024
    ds_write_b128 v106, v[88:91] offset:2048
    ds_write_b128 v106, v[92:95] offset:3072
    ds_write_b128 v106, v[96:99] offset:4096
    ds_write_b128 v106, v[100:103] offset:5120
    s_waitcnt lgkmcnt(0)
    s_barrier
    s_cmp_ge_u32 s46, 3
    s_cbranch_scc1 K2_END
    ds_read_b128 v[0:3], v107 offset:0
    ds_read_b128 v[4:7], v107 offset:1024
    ds_read_b128 v[8:11], v107 offset:6144
    ds_read_b128 v[12:15], v107 offset:7168
    ds_read_b128 v[16:19], v107 offset:12288
    ds_read_b128 v[20:23], v107 offset:13312
    ds_read_b128 v[24:27], v107 offset:18432
    ds_read_b128 v[28:31], v107 offset:19456
    s_waitcnt lgkmcnt(0)
    v_pk_add_f32 v[0:1], v[0:1], v[16:17]
    v_pk_add_f32 v[2:3], v[2:3], v[18:19]
    v_pk_add_f32 v[4:5], v[4:5], v[20:21]
    v_pk_add_f32 v[6:7], v[6:7], v[22:23]
    v_pk_add_f32 v[8:9], v[8:9], v[24:25]
    v_pk_add_f32 v[10:11], v[10:11], v[26:27]
    v_pk_add_f32 v[12:13], v[12:13], v[28:29]
    v_pk_add_f32 v[14:15], v[14:15], v[30:31]
    v_pk_add_f32 v[0:1], v[0:1], v[8:9]
    v_pk_add_f32 v[2:3], v[2:3], v[10:11]
    v_pk_add_f32 v[4:5], v[4:5], v[12:13]
    v_pk_add_f32 v[6:7], v[6:7], v[14:15]
    v_cvt_pk_bf16_f32 v8, v0, v1
    v_cvt_pk_bf16_f32 v9, v2, v3
    v_cvt_pk_bf16_f32 v10, v4, v5
    v_cvt_pk_bf16_f32 v11, v6, v7
    buffer_store_dwordx4 v[8:11], v105, s[24:27], s52 offen offset:0
K2_END:
    s_endpgm
.section .rodata,"a"
.p2align 6
.amdhsa_kernel standalone__gqa_block_cached__near_ridge_kernel
  .amdhsa_next_free_vgpr 256
  .amdhsa_next_free_sgpr 102
  .amdhsa_accum_offset 256
  .amdhsa_group_segment_fixed_size 0
  .amdhsa_kernarg_size 64
  .amdhsa_user_sgpr_count 2
  .amdhsa_user_sgpr_kernarg_segment_ptr 1
  .amdhsa_system_sgpr_workgroup_id_x 1
.end_amdhsa_kernel
.p2align 6
.amdhsa_kernel oproj_kernel
  .amdhsa_next_free_vgpr 256
  .amdhsa_next_free_sgpr 102
  .amdhsa_accum_offset 256
  .amdhsa_group_segment_fixed_size 0
  .amdhsa_kernarg_size 64
  .amdhsa_user_sgpr_count 2
  .amdhsa_user_sgpr_kernarg_segment_ptr 1
  .amdhsa_system_sgpr_workgroup_id_x 1
.end_amdhsa_kernel
```
